```python
import torch

def _softmax(x, axis=-1):
    return torch.softmax(x, dim=axis)
def _gelu(x):
    return torch.nn.functional.gelu(x, approximate="tanh")
def _silu(x):
    return torch.nn.functional.silu(x)
def _sigmoid(x):
    return torch.sigmoid(x)
def _layernorm(x, axis=-1, eps=1e-5):
    m = x.mean(dim=axis, keepdim=True)
    v = x.var(dim=axis, keepdim=True, unbiased=False)
    return (x - m) / torch.sqrt(v + eps)
def _scatter_add(tgt, idx, src, axis=0):
    return tgt.clone().index_add_(axis, idx, src)
def _segment_sum(src, seg, n):
    out = torch.zeros((n,) + src.shape[1:], dtype=src.dtype)
    return out.index_add_(0, seg, src)
def _pad(x, pw):
    flat = tuple(v for pair in reversed(pw) for v in pair)
    return torch.nn.functional.pad(x, flat)

kernel_name = 'sequential_preLN__ssm_conv_s4__mixer_channel_mlp__prompt'

def setup_inputs():

    _w = (lambda a: (lambda t: t.to(torch.bfloat16) if t.is_floating_point() else t)(torch.as_tensor(a)))
    def _A_setup():
        B, L, D, N = 1, 2048, 512, 128
        A_re = -(lambda _x: torch.exp(torch.as_tensor(_x)))((lambda *s: torch.randn(*s, dtype=torch.bfloat16) * 3.2)(D, N))
        A_im = torch.pi * (lambda *s: torch.randn(*s, dtype=torch.bfloat16) * 0.05)(D, N)
        B_re = (lambda *s: torch.randn(*s, dtype=torch.bfloat16) * 0.1)(D, N)
        B_im = (lambda *s: torch.randn(*s, dtype=torch.bfloat16) * 0.1)(D, N)
        C_re = (lambda *s: torch.randn(*s, dtype=torch.bfloat16) * 0.1)(D, N)
        C_im = (lambda *s: torch.randn(*s, dtype=torch.bfloat16) * 0.1)(D, N)
        log_dt = (lambda *s: torch.randn(*s, dtype=torch.bfloat16) * 0.05)(D) * 0.5 - 4.0
        Dskip = (lambda *s: torch.randn(*s, dtype=torch.bfloat16) * 0.05)(D)
        return {
            "u": _w((lambda *s: torch.randn(*s, dtype=torch.bfloat16) * 0.05)(B, L, D)),
            "A_re": _w(A_re),
            "A_im": _w(A_im),
            "B_re": _w(B_re),
            "B_im": _w(B_im),
            "C_re": _w(C_re),
            "C_im": _w(C_im),
            "log_dt": _w(log_dt),
            "Dskip": _w(Dskip),
        }
    _A_in = _A_setup()

    def _B_setup():
        B, S, D, F = 1, 2048, 512, 1792
        return {
            "x": _w((lambda *s: torch.randn(*s, dtype=torch.bfloat16) * 0.05)(B, S, D)),
            "w1": _w((lambda *s: torch.randn(*s, dtype=torch.bfloat16) * 1.6)(D, F) * (D ** -0.5)),
            "b1": _w((lambda *s: torch.randn(*s, dtype=torch.bfloat16) * 0.8)(F)),
            "w2": _w((lambda *s: torch.randn(*s, dtype=torch.bfloat16) * 0.05)(F, D) * (F ** -0.5)),
            "b2": _w((lambda *s: torch.randn(*s, dtype=torch.bfloat16) * 0.05)(D)),
        }
    _B_in = _B_setup()

    return {
        "A_u": _A_in["u"],
        "A_A_re": _A_in["A_re"],
        "A_A_im": _A_in["A_im"],
        "A_B_re": _A_in["B_re"],
        "A_B_im": _A_in["B_im"],
        "A_C_re": _A_in["C_re"],
        "A_C_im": _A_in["C_im"],
        "A_log_dt": _A_in["log_dt"],
        "A_Dskip": _A_in["Dskip"],
        "B_x": _B_in["x"],
        "B_w1": _B_in["w1"],
        "B_b1": _B_in["b1"],
        "B_w2": _B_in["w2"],
        "B_b2": _B_in["b2"],
    }

def reference(A_u, A_A_re, A_A_im, A_B_re, A_B_im, A_C_re, A_C_im, A_log_dt, A_Dskip, B_x, B_w1, B_b1, B_w2, B_b2):
    def _A_ref(u, A_re, A_im, B_re, B_im, C_re, C_im, log_dt, Dskip):
        Bsz, L, D = u.shape
        dt = torch.exp(log_dt)[:, None]
        A = A_re + 1j * A_im
        Bc = B_re + 1j * B_im
        Cc = C_re + 1j * C_im
        logdA = dt * A
        dB = dt * Bc
        l = (lambda x, dt: x.to(dt))(torch.arange(L), A_re.dtype)
        P = torch.exp(logdA[:, :, None] * l[None, None, :])
        K = torch.einsum("dn,dnl,dn->dl", Cc, P, dB).real
        L2 = 2 * L
        Kp = _pad(K, ((0, 0), (0, L)))
        up = (lambda x, *d: x.permute(*d))(u, 0, 2, 1)
        up = _pad(up, ((0, 0), (0, 0), (0, L)))
        Kf = (lambda x, axes=(-2,-1): torch.fft.rfft2(x.float(), dim=axes))(Kp[:, None, :], axes=(-2, -1))
        Uf = (lambda x, axes=(-2,-1): torch.fft.rfft2(x.float(), dim=axes))(up[:, :, None, :], axes=(-2, -1))
        Yf = Uf * Kf[None, :, :, :]
        y = (lambda x, s, axes=(-2,-1): torch.fft.irfft2(x, s=s, dim=axes).to(torch.bfloat16))(Yf, (1, L2), axes=(-2, -1))[:, :, 0, :L]
        y = (lambda x, *d: x.permute(*d))(y, 0, 2, 1) + u * Dskip[None, None, :]
        return y

    def _B_ref(x, w1, b1, w2, b2):
        y = _layernorm(x, axis=-1)
        h = _gelu(torch.einsum("bsd,df->bsf", y, w1) + b1)
        return torch.einsum("bsf,fd->bsd", h, w2) + b2

    x = A_u
    h = x + _A_ref(_layernorm(x, axis=-1), A_A_re, A_A_im, A_B_re, A_B_im, A_C_re, A_C_im, A_log_dt, A_Dskip)
    h2 = h + _B_ref(_layernorm(h, axis=-1), B_w1, B_b1, B_w2, B_b2)
    return h2
```

```asm
; @launch grid=(256,1,1) block=(256,1,1) lds=163840
.amdgcn_target "amdgcn-amd-amdhsa--gfx950"
.text
.globl sequential_preLN__ssm_conv_s4__mixer_channel_mlp__prompt_kernel
.p2align 8
.type sequential_preLN__ssm_conv_s4__mixer_channel_mlp__prompt_kernel,@function
sequential_preLN__ssm_conv_s4__mixer_channel_mlp__prompt_kernel:
    s_getpc_b64 s[92:93]
L_pc1:
    s_load_dwordx16 s[4:19], s[0:1], 0
    s_load_dwordx16 s[20:35], s[0:1], 64
    s_load_dwordx2 s[36:37], s[0:1], 128
    s_cmp_ge_u32 s2, 256
    s_cbranch_scc1 L_end
    v_and_b32 v1, 63, v0
    v_lshrrev_b32 v2, 6, v0
    s_and_b32 s40, s2, 7
    s_lshr_b32 s41, s2, 3
    v_readfirstlane_b32 s39, v2
    s_lshl_b32 s63, s41, 2
    s_add_u32 s63, s63, s39
    s_mul_i32 s63, s63, 256
    v_lshlrev_b32 v19, 7, v1
    v_add_u32 v19, s63, v19
    v_min_u32 v19, L_gtab-L_pc1, v19
    s_mov_b64 exec, 3
    global_load_dword v247, v19, s[92:93]
    s_mov_b64 exec, -1
    s_lshl_b32 s63, s2, 3
    v_lshlrev_b32 v2, 4, v1
    s_mov_b32 s50, 0x200000
    s_mov_b32 s51, 0x00020000
    s_lshl_b32 s64, s39, 1
    s_add_u32 s63, s63, s64
    s_lshl_b32 s64, s63, 10
    s_lshl_b32 s42, s40, 5
    s_add_u32 s42, s42, s41
    s_lshl_b32 s60, s42, 2
    s_lshr_b32 s65, s39, 1
    s_lshl_b32 s66, s42, 1
    s_add_u32 s66, s66, s65
    s_lshl_b32 s66, s66, 8
    s_and_b32 s67, s39, 1
    s_lshl_b32 s67, s67, 7
    s_add_u32 s66, s66, s67
    v_lshlrev_b32 v3, 1, v1
    v_add_u32 v3, s66, v3
    s_waitcnt lgkmcnt(0)
    global_load_ushort v238, v3, s[6:7]
    global_load_ushort v239, v3, s[8:9]
    s_mov_b32 s48, s4
    s_mov_b32 s49, s5
    global_load_ushort v240, v3, s[10:11]
    global_load_ushort v241, v3, s[12:13]
    global_load_ushort v242, v3, s[14:15]
    global_load_ushort v243, v3, s[16:17]
    buffer_load_dwordx4 v[4:7], v2, s[48:51], s64 offen
    buffer_load_dwordx4 v[8:11], v2, s[48:51], s64 offen offset:1024
    s_load_dword s38, s[36:37], 0
    s_load_dword s61, s[18:19], s60
    s_load_dword s62, s[20:21], s60
    s_add_u32 s68, s92, L_gtab-L_pc1
    s_addc_u32 s69, s93, 0
    v_lshlrev_b32 v33, 5, v0
    global_load_dwordx4 v[28:31], v33, s[68:69]
    global_load_dword v32, v33, s[68:69] offset:16
    s_and_b32 s72, s39, 1
    s_cmp_eq_u32 s72, 0
    s_cselect_b32 s74, s24, s28
    s_cselect_b32 s75, s25, s29
    s_mul_i32 s72, s2, 7168
    s_lshr_b32 s73, s39, 1
    s_mul_i32 s73, s73, 3584
    s_add_u32 s72, s72, s73
    v_lshlrev_b32 v227, 7, v1
    v_add_u32 v227, s72, v227
    s_mov_b32 exec_lo, 0x0fffffff
    s_mov_b32 exec_hi, 0
    global_load_dword v227, v227, s[74:75]
    s_mov_b64 exec, -1
    s_mov_b32 s44, s36
    s_mov_b32 s45, s37
    s_mov_b32 s46, 0x10000000
    s_mov_b32 s47, 0x00020000
    s_mov_b32 s52, s28
    s_mov_b32 s53, s29
    s_mov_b32 s54, 1835008
    s_mov_b32 s55, 0x00020000
    s_mov_b32 s56, s24
    s_mov_b32 s57, s25
    s_mov_b32 s58, 1835008
    s_mov_b32 s59, 0x00020000
    v_lshrrev_b32 v228, 3, v1
    v_and_b32 v229, 7, v1
    v_lshrrev_b32 v230, 1, v228
    v_and_b32 v230, 1, v230
    v_lshlrev_b32 v230, 2, v230
    v_xor_b32 v229, v229, v230
    v_lshlrev_b32 v229, 4, v229
    v_lshlrev_b32 v228, 10, v228
    v_add_u32 v16, v228, v229
    s_and_b32 s91, s41, 7
    s_lshr_b32 s88, s41, 3
    s_mul_i32 s88, s88, 7
    s_lshl_b32 s91, s91, 7
    s_mul_i32 s86, s39, 458752
    s_add_u32 s86, s86, s91
    v_add_u32 v16, s86, v16
    v_add_u32 v19, 7168, v16
    s_lshl_b32 s90, s88, 14
    v_lshrrev_b32 v228, 4, v1
    v_lshrrev_b32 v229, 1, v228
    v_and_b32 v228, 1, v228
    v_and_b32 v230, 15, v1
    v_lshrrev_b32 v231, 2, v230
    v_and_b32 v230, 3, v230
    v_lshlrev_b32 v232, 2, v229
    v_add_u32 v232, v232, v231
    v_lshlrev_b32 v232, 7, v232
    v_lshlrev_b32 v228, 1, v228
    v_lshrrev_b32 v233, 1, v230
    v_add_u32 v228, v228, v233
    v_lshrrev_b32 v233, 1, v231
    v_and_b32 v233, 1, v233
    v_lshlrev_b32 v233, 2, v233
    v_xor_b32 v228, v228, v233
    v_lshlrev_b32 v228, 4, v228
    v_and_b32 v230, 1, v230
    v_lshlrev_b32 v230, 3, v230
    v_add3_u32 v232, v232, v228, v230
    s_lshr_b32 s91, s39, 1
    s_lshl_b32 s91, s91, 6
    v_xor_b32 v17, s91, v232
    v_xor_b32 v18, 64, v17
    v_and_b32 v228, 15, v1
    v_lshrrev_b32 v229, 4, v1
    v_and_b32 v235, 1, v229
    v_lshlrev_b32 v235, 1, v235
    v_lshrrev_b32 v236, 1, v229
    v_or_b32 v235, v235, v236
    s_lshr_b32 s65, s39, 1
    s_and_b32 s66, s39, 1
    s_mul_i32 s67, s65, 8320
    s_lshl_b32 s68, s66, 8
    s_add_u32 s67, s67, s68
    s_add_u32 s67, s67, 52
    v_and_b32 v236, 1, v228
    v_xor_b32 v236, 1, v236
    v_mul_u32_u24 v236, 4160, v236
    v_lshrrev_b32 v237, 1, v228
    v_lshlrev_b32 v226, 2, v235
    v_sub_u32 v237, v237, v226
    v_lshlrev_b32 v237, 2, v237
    v_add3_u32 v230, v236, v237, s67
    v_add_u32 v231, 1024, v230
    v_add_u32 v232, 2048, v230
    v_add_u32 v233, 3072, v230
    s_mul_i32 s67, s65, 4736
    s_lshl_b32 s68, s66, 7
    s_sub_u32 s67, s67, s68
    s_add_u32 s67, s67, 17040
    v_and_b32 v236, 1, v235
    v_mul_u32_u24 v236, 2368, v236
    v_lshrrev_b32 v237, 1, v235
    v_add_u32 v237, v237, v228
    v_lshlrev_b32 v237, 4, v237
    v_add3_u32 v234, v236, v237, s67
    v_mov_b32 v36, 0
    v_mov_b32 v37, 0
    v_mov_b32 v38, 0
    v_mov_b32 v39, 0
    v_lshlrev_b32 v33, 4, v1
    v_and_b32 v33, 0x1ff, v33
    v_add_u32 v33, 68416, v33
    ds_write_b128 v33, v[36:39]
    s_mul_i32 s65, s39, 2080
    s_add_u32 s65, s65, 57664
    v_add_u32 v71, s65, v2
    v_and_b32 v72, 3, v1
    v_mul_u32_u24 v72, 2080, v72
    v_lshrrev_b32 v73, 2, v1
    s_lshl_b32 s65, s39, 8
    s_add_u32 s65, s65, 57664
    v_lshlrev_b32 v74, 2, v73
    v_add3_u32 v72, v72, v74, s65
    v_lshlrev_b32 v73, 14, v73
    v_and_b32 v74, 3, v1
    v_lshlrev_b32 v74, 4, v74
    s_lshl_b32 s65, s39, 20
    s_lshl_b32 s66, s2, 6
    s_add_u32 s65, s65, s66
    s_add_u32 s65, s65, 12582912
    v_add3_u32 v73, v73, v74, s65
    s_lshl_b32 s76, s39, 4
    s_lshl_b32 s77, s2, 6
    s_add_u32 s76, s76, s77
    s_add_u32 s76, s76, 65536
    v_mov_b32 v70, 0
    v_mov_b32 v62, 0x3b000000
    s_mov_b32 s65, 0
    s_mov_b32 s66, 0x40000
    s_mov_b32 s67, 0x80000
    s_mov_b32 s77, 0xc0000
    s_waitcnt lgkmcnt(0)
    s_add_u32 s38, s38, 2654435769
    v_mov_b32 v77, s38
    v_mov_b32 v79, s38
    v_mov_b32 v81, s38
    v_mov_b32 v83, s38
    v_mov_b32 v85, s38
    v_mov_b32 v87, s38
    v_mov_b32 v89, s38
    v_mov_b32 v91, s38
    v_mov_b32 v67, s38
    v_mov_b32 v69, s38
    s_waitcnt vmcnt(3)
    ds_write_b128 v71, v[4:7]
    ds_write_b128 v71, v[8:11] offset:1040
    v_lshlrev_b32 v40, 16, v4
    v_and_b32 v41, 0xffff0000, v4
    v_lshlrev_b32 v42, 16, v5
    v_and_b32 v43, 0xffff0000, v5
    v_lshlrev_b32 v44, 16, v6
    v_and_b32 v45, 0xffff0000, v6
    v_lshlrev_b32 v46, 16, v7
    v_and_b32 v47, 0xffff0000, v7
    v_lshlrev_b32 v48, 16, v8
    v_and_b32 v49, 0xffff0000, v8
    v_lshlrev_b32 v50, 16, v9
    v_and_b32 v51, 0xffff0000, v9
    v_lshlrev_b32 v52, 16, v10
    v_and_b32 v53, 0xffff0000, v10
    v_lshlrev_b32 v54, 16, v11
    v_and_b32 v55, 0xffff0000, v11
    v_readfirstlane_b32 s74, v40
    v_readfirstlane_b32 s75, v48
    s_waitcnt lgkmcnt(0)
    s_barrier
    ds_read_b32 v76, v72 offset:0
    ds_read_b32 v78, v72 offset:1040
    ds_read_b32 v80, v72 offset:64
    ds_read_b32 v82, v72 offset:1104
    ds_read_b32 v84, v72 offset:128
    ds_read_b32 v86, v72 offset:1168
    ds_read_b32 v88, v72 offset:192
    ds_read_b32 v90, v72 offset:1232
    v_mov_b32 v64, s74
    v_mov_b32 v65, s75
    v_pk_add_f32 v[40:41], v[40:41], v[64:65] op_sel:[0,0] op_sel_hi:[1,0] neg_lo:[0,1] neg_hi:[0,1]
    v_pk_add_f32 v[42:43], v[42:43], v[64:65] op_sel:[0,0] op_sel_hi:[1,0] neg_lo:[0,1] neg_hi:[0,1]
    v_pk_add_f32 v[44:45], v[44:45], v[64:65] op_sel:[0,0] op_sel_hi:[1,0] neg_lo:[0,1] neg_hi:[0,1]
    v_pk_add_f32 v[46:47], v[46:47], v[64:65] op_sel:[0,0] op_sel_hi:[1,0] neg_lo:[0,1] neg_hi:[0,1]
    v_pk_add_f32 v[48:49], v[48:49], v[64:65] op_sel:[0,1] op_sel_hi:[1,1] neg_lo:[0,1] neg_hi:[0,1]
    v_pk_add_f32 v[50:51], v[50:51], v[64:65] op_sel:[0,1] op_sel_hi:[1,1] neg_lo:[0,1] neg_hi:[0,1]
    v_pk_add_f32 v[52:53], v[52:53], v[64:65] op_sel:[0,1] op_sel_hi:[1,1] neg_lo:[0,1] neg_hi:[0,1]
    v_pk_add_f32 v[54:55], v[54:55], v[64:65] op_sel:[0,1] op_sel_hi:[1,1] neg_lo:[0,1] neg_hi:[0,1]
    s_waitcnt lgkmcnt(0)
    buffer_store_dwordx4 v[76:79], v73, s[44:47], s65 offen sc1
    buffer_store_dwordx4 v[80:83], v73, s[44:47], s66 offen sc1
    buffer_store_dwordx4 v[84:87], v73, s[44:47], s67 offen sc1
    buffer_store_dwordx4 v[88:91], v73, s[44:47], s77 offen sc1
    v_pk_add_f32 v[56:57], v[40:41], v[42:43]
    v_pk_mul_f32 v[60:61], v[40:41], v[40:41]
    v_pk_add_f32 v[58:59], v[48:49], v[50:51]
    v_pk_mul_f32 v[92:93], v[48:49], v[48:49]
    v_pk_fma_f32 v[60:61], v[42:43], v[42:43], v[60:61]
    v_pk_fma_f32 v[92:93], v[50:51], v[50:51], v[92:93]
    v_pk_add_f32 v[56:57], v[56:57], v[44:45]
    v_pk_fma_f32 v[60:61], v[44:45], v[44:45], v[60:61]
    v_pk_add_f32 v[58:59], v[58:59], v[52:53]
    v_pk_fma_f32 v[92:93], v[52:53], v[52:53], v[92:93]
    v_pk_add_f32 v[56:57], v[56:57], v[46:47]
    v_pk_fma_f32 v[60:61], v[46:47], v[46:47], v[60:61]
    v_pk_add_f32 v[58:59], v[58:59], v[54:55]
    v_pk_fma_f32 v[92:93], v[54:55], v[54:55], v[92:93]
    v_add_f32 v56, v56, v57
    v_add_f32 v58, v58, v59
    v_add_f32 v60, v60, v61
    v_add_f32 v92, v92, v93
    v_add_f32_dpp v56, v56, v56 row_shr:1 row_mask:0xf bank_mask:0xf bound_ctrl:0
    v_add_f32_dpp v58, v58, v58 row_shr:1 row_mask:0xf bank_mask:0xf bound_ctrl:0
    v_add_f32_dpp v60, v60, v60 row_shr:1 row_mask:0xf bank_mask:0xf bound_ctrl:0
    v_add_f32_dpp v92, v92, v92 row_shr:1 row_mask:0xf bank_mask:0xf bound_ctrl:0
    v_add_f32_dpp v56, v56, v56 row_shr:2 row_mask:0xf bank_mask:0xf bound_ctrl:0
    v_add_f32_dpp v58, v58, v58 row_shr:2 row_mask:0xf bank_mask:0xf bound_ctrl:0
    v_add_f32_dpp v60, v60, v60 row_shr:2 row_mask:0xf bank_mask:0xf bound_ctrl:0
    v_add_f32_dpp v92, v92, v92 row_shr:2 row_mask:0xf bank_mask:0xf bound_ctrl:0
    v_add_f32_dpp v56, v56, v56 row_shr:4 row_mask:0xf bank_mask:0xf bound_ctrl:0
    v_add_f32_dpp v58, v58, v58 row_shr:4 row_mask:0xf bank_mask:0xf bound_ctrl:0
    v_add_f32_dpp v60, v60, v60 row_shr:4 row_mask:0xf bank_mask:0xf bound_ctrl:0
    v_add_f32_dpp v92, v92, v92 row_shr:4 row_mask:0xf bank_mask:0xf bound_ctrl:0
    v_add_f32_dpp v56, v56, v56 row_shr:8 row_mask:0xf bank_mask:0xf bound_ctrl:0
    v_add_f32_dpp v58, v58, v58 row_shr:8 row_mask:0xf bank_mask:0xf bound_ctrl:0
    v_add_f32_dpp v60, v60, v60 row_shr:8 row_mask:0xf bank_mask:0xf bound_ctrl:0
    v_add_f32_dpp v92, v92, v92 row_shr:8 row_mask:0xf bank_mask:0xf bound_ctrl:0
    v_add_f32_dpp v56, v56, v56 row_bcast:15 row_mask:0xa bank_mask:0xf
    v_add_f32_dpp v58, v58, v58 row_bcast:15 row_mask:0xa bank_mask:0xf
    v_add_f32_dpp v60, v60, v60 row_bcast:15 row_mask:0xa bank_mask:0xf
    v_add_f32_dpp v92, v92, v92 row_bcast:15 row_mask:0xa bank_mask:0xf
    v_add_f32_dpp v56, v56, v56 row_bcast:31 row_mask:0xc bank_mask:0xf
    v_add_f32_dpp v58, v58, v58 row_bcast:31 row_mask:0xc bank_mask:0xf
    v_add_f32_dpp v60, v60, v60 row_bcast:31 row_mask:0xc bank_mask:0xf
    v_add_f32_dpp v92, v92, v92 row_bcast:31 row_mask:0xc bank_mask:0xf
    v_mul_f32 v56, v56, v62
    v_mul_f32 v58, v58, v62
    v_mul_f32 v60, v60, v62
    v_mul_f32 v92, v92, v62
    v_fma_f32 v60, -v56, v56, v60
    v_fma_f32 v92, -v58, v58, v92
    v_add_f32 v56, v56, v64
    v_add_f32 v58, v58, v65
    v_max_f32 v60, 0, v60
    v_max_f32 v92, 0, v92
    v_cvt_pk_bf16_f32 v60, v60, v60
    v_cvt_pk_bf16_f32 v92, v92, v92
    v_lshlrev_b32 v60, 16, v60
    v_lshlrev_b32 v92, 16, v92
    v_add_f32 v60, 0x3727c5ac, v60
    v_add_f32 v92, 0x3727c5ac, v92
    v_cvt_pk_bf16_f32 v60, v60, v60
    v_cvt_pk_bf16_f32 v92, v92, v92
    v_lshlrev_b32 v60, 16, v60
    v_lshlrev_b32 v92, 16, v92
    v_sqrt_f32 v60, v60
    v_sqrt_f32 v92, v92
    v_cvt_pk_bf16_f32 v66, v56, v60
    v_cvt_pk_bf16_f32 v68, v58, v92
    s_mov_b64 s[72:73], exec
    s_mov_b32 exec_lo, 0
    s_mov_b32 exec_hi, 0x80000000
    buffer_store_dwordx4 v[66:69], v70, s[44:47], s76 offen sc1
    s_mov_b64 exec, s[72:73]
    v_lshlrev_b32 v12, 16, v238
    v_lshlrev_b32 v13, 16, v239
    v_lshlrev_b32 v14, 16, v240
    v_lshlrev_b32 v15, 16, v241
    v_lshlrev_b32 v38, 16, v242
    v_lshlrev_b32 v39, 16, v243
    s_lshr_b32 s65, s39, 1
    s_lshl_b32 s77, s61, 16
    s_and_b32 s78, s61, 0xffff0000
    s_cmp_eq_u32 s65, 0
    s_cselect_b32 s77, s77, s78
    v_mov_b32 v40, s77
    v_mul_f32 v41, 0x3fb8aa3b, v40
    v_mov_b32 v43, 0x3fb8aa3b
    v_fma_f32 v42, v40, v43, -v41
    v_fmac_f32 v42, 0x32a57060, v40
    v_exp_f32 v41, v41
    v_mul_f32 v42, 0x3f317218, v42
    v_fma_f32 v41, v41, v42, v41
    v_cvt_pk_bf16_f32 v41, v41, v41
    v_lshlrev_b32 v41, 16, v41
    v_mul_f32 v44, v41, v12
    v_mul_f32 v45, v41, v13
    v_mul_f32 v46, v41, v14
    v_mul_f32 v47, v41, v15
    v_mul_f32 v44, 0x3fb8aa3b, v44
    v_mul_f32 v45, 0x3e22f983, v45
    v_mul_f32 v48, v38, v46
    v_mul_f32 v49, v38, v47
    v_fma_f32 v48, -v39, v47, v48
    v_fma_f32 v49, v39, v46, v49
    v_max_f32 v50, |v48|, |v49|
    v_mul_f32 v196, 0x41000000, v44
    v_mul_f32 v197, 0x41000000, v45
    v_mul_f32 v198, 0x3f800000, v44
    v_mul_f32 v199, 0x3f800000, v45
    v_mul_f32 v200, 0x43800000, v44
    v_mul_f32 v201, 0x43800000, v45
    v_fract_f32 v197, v197
    v_fract_f32 v199, v199
    v_fract_f32 v201, v201
    v_exp_f32 v196, v196
    v_exp_f32 v198, v198
    v_exp_f32 v200, v200
    v_cos_f32 v66, v197
    v_sin_f32 v67, v197
    v_cos_f32 v172, v199
    v_sin_f32 v173, v199
    v_cos_f32 v178, v201
    v_sin_f32 v179, v201
    v_pk_mul_f32 v[66:67], v[66:67], v[196:197] op_sel_hi:[1,0]
    v_pk_mul_f32 v[172:173], v[172:173], v[198:199] op_sel_hi:[1,0]
    v_pk_mul_f32 v[178:179], v[178:179], v[200:201] op_sel_hi:[1,0]
    v_max_f32_dpp v50, v50, v50 row_shr:1 row_mask:0xf bank_mask:0xf
    s_nop 1
    v_max_f32_dpp v50, v50, v50 row_shr:2 row_mask:0xf bank_mask:0xf
    s_nop 1
    v_max_f32_dpp v50, v50, v50 row_shr:4 row_mask:0xf bank_mask:0xf
    s_nop 1
    v_max_f32_dpp v50, v50, v50 row_shr:8 row_mask:0xf bank_mask:0xf
    s_nop 1
    v_max_f32_dpp v50, v50, v50 row_bcast:15 row_mask:0xa bank_mask:0xf
    s_nop 1
    v_max_f32_dpp v50, v50, v50 row_bcast:31 row_mask:0xc bank_mask:0xf
    s_nop 0
    v_readlane_b32 s79, v50, 63
    s_mul_i32 s80, s39, 14416
    s_mov_b32 m0, s80
    v_mov_b32 v50, s79
    v_frexp_exp_i32_f32 v50, v50
    v_mov_b32 v64, 1.0
    v_mov_b32 v65, 0
    v_sub_u32 v51, 10, v50
    v_sub_u32 v52, 0, v51
    v_ldexp_f32 v128, v48, v51
    v_ldexp_f32 v129, v49, v51
    v_pk_mul_f32 v[174:175], v[172:173], v[172:173] op_sel:[0,0] op_sel_hi:[0,1]
    v_pk_mul_f32 v[68:69], v[66:67], v[66:67] op_sel:[0,0] op_sel_hi:[0,1]
    v_pk_mul_f32 v[180:181], v[178:179], v[178:179] op_sel:[0,0] op_sel_hi:[0,1]
    v_pk_mul_f32 v[130:131], v[128:129], v[172:173] op_sel:[0,0] op_sel_hi:[0,1]
    v_pk_fma_f32 v[174:175], v[172:173], v[172:173], v[174:175] op_sel:[1,1,0] op_sel_hi:[1,0,1] neg_lo:[1,0,0]
    v_pk_fma_f32 v[68:69], v[66:67], v[66:67], v[68:69] op_sel:[1,1,0] op_sel_hi:[1,0,1] neg_lo:[1,0,0]
    v_pk_fma_f32 v[180:181], v[178:179], v[178:179], v[180:181] op_sel:[1,1,0] op_sel_hi:[1,0,1] neg_lo:[1,0,0]
    v_pk_fma_f32 v[130:131], v[128:129], v[172:173], v[130:131] op_sel:[1,1,0] op_sel_hi:[1,0,1] neg_lo:[1,0,0]
    v_pk_mul_f32 v[176:177], v[174:175], v[174:175] op_sel:[0,0] op_sel_hi:[0,1]
    v_cvt_pk_f16_f32 v210, v64, -v65
    ds_write_addtid_b32 v210 offset:0
    v_pk_mul_f32 v[70:71], v[68:69], v[66:67] op_sel:[0,0] op_sel_hi:[0,1]
    v_pk_mul_f32 v[72:73], v[68:69], v[68:69] op_sel:[0,0] op_sel_hi:[0,1]
    v_pk_mul_f32 v[182:183], v[180:181], v[178:179] op_sel:[0,0] op_sel_hi:[0,1]
    v_cvt_pk_f16_f32 v211, v66, -v67
    ds_write_addtid_b32 v211 offset:272
    v_pk_mul_f32 v[184:185], v[180:181], v[180:181] op_sel:[0,0] op_sel_hi:[0,1]
    v_pk_mul_f32 v[132:133], v[128:129], v[174:175] op_sel:[0,0] op_sel_hi:[0,1]
    v_pk_mul_f32 v[134:135], v[130:131], v[174:175] op_sel:[0,0] op_sel_hi:[0,1]
    v_cvt_pk_f16_f32 v212, v128, v129
    ds_write_addtid_b32 v212 offset:8704
    v_pk_fma_f32 v[176:177], v[174:175], v[174:175], v[176:177] op_sel:[1,1,0] op_sel_hi:[1,0,1] neg_lo:[1,0,0]
    v_pk_fma_f32 v[70:71], v[68:69], v[66:67], v[70:71] op_sel:[1,1,0] op_sel_hi:[1,0,1] neg_lo:[1,0,0]
    v_pk_fma_f32 v[72:73], v[68:69], v[68:69], v[72:73] op_sel:[1,1,0] op_sel_hi:[1,0,1] neg_lo:[1,0,0]
    v_pk_fma_f32 v[182:183], v[180:181], v[178:179], v[182:183] op_sel:[1,1,0] op_sel_hi:[1,0,1] neg_lo:[1,0,0]
    v_pk_fma_f32 v[184:185], v[180:181], v[180:181], v[184:185] op_sel:[1,1,0] op_sel_hi:[1,0,1] neg_lo:[1,0,0]
    v_pk_fma_f32 v[132:133], v[128:129], v[174:175], v[132:133] op_sel:[1,1,0] op_sel_hi:[1,0,1] neg_lo:[1,0,0]
    v_pk_fma_f32 v[134:135], v[130:131], v[174:175], v[134:135] op_sel:[1,1,0] op_sel_hi:[1,0,1] neg_lo:[1,0,0]
    v_pk_mul_f32 v[74:75], v[72:73], v[66:67] op_sel:[0,0] op_sel_hi:[0,1]
    v_cvt_pk_f16_f32 v213, v68, -v69
    ds_write_addtid_b32 v213 offset:544
    v_pk_mul_f32 v[76:77], v[70:71], v[70:71] op_sel:[0,0] op_sel_hi:[0,1]
    v_pk_mul_f32 v[78:79], v[72:73], v[70:71] op_sel:[0,0] op_sel_hi:[0,1]
    v_pk_mul_f32 v[80:81], v[72:73], v[72:73] op_sel:[0,0] op_sel_hi:[0,1]
    v_cvt_pk_f16_f32 v214, v130, v131
    ds_write_addtid_b32 v214 offset:8976
    v_pk_mul_f32 v[136:137], v[128:129], v[176:177] op_sel:[0,0] op_sel_hi:[0,1]
    v_pk_mul_f32 v[138:139], v[130:131], v[176:177] op_sel:[0,0] op_sel_hi:[0,1]
    v_pk_mul_f32 v[140:141], v[132:133], v[176:177] op_sel:[0,0] op_sel_hi:[0,1]
    v_pk_mul_f32 v[142:143], v[134:135], v[176:177] op_sel:[0,0] op_sel_hi:[0,1]
    v_pk_fma_f32 v[74:75], v[72:73], v[66:67], v[74:75] op_sel:[1,1,0] op_sel_hi:[1,0,1] neg_lo:[1,0,0]
    v_pk_fma_f32 v[76:77], v[70:71], v[70:71], v[76:77] op_sel:[1,1,0] op_sel_hi:[1,0,1] neg_lo:[1,0,0]
    v_pk_fma_f32 v[78:79], v[72:73], v[70:71], v[78:79] op_sel:[1,1,0] op_sel_hi:[1,0,1] neg_lo:[1,0,0]
    v_pk_fma_f32 v[80:81], v[72:73], v[72:73], v[80:81] op_sel:[1,1,0] op_sel_hi:[1,0,1] neg_lo:[1,0,0]
    v_pk_fma_f32 v[136:137], v[128:129], v[176:177], v[136:137] op_sel:[1,1,0] op_sel_hi:[1,0,1] neg_lo:[1,0,0]
    v_pk_fma_f32 v[138:139], v[130:131], v[176:177], v[138:139] op_sel:[1,1,0] op_sel_hi:[1,0,1] neg_lo:[1,0,0]
    v_pk_fma_f32 v[140:141], v[132:133], v[176:177], v[140:141] op_sel:[1,1,0] op_sel_hi:[1,0,1] neg_lo:[1,0,0]
    v_pk_fma_f32 v[142:143], v[134:135], v[176:177], v[142:143] op_sel:[1,1,0] op_sel_hi:[1,0,1] neg_lo:[1,0,0]
    v_pk_mul_f32 v[82:83], v[80:81], v[66:67] op_sel:[0,0] op_sel_hi:[0,1]
    v_cvt_pk_f16_f32 v215, v70, -v71
    ds_write_addtid_b32 v215 offset:816
    v_pk_mul_f32 v[84:85], v[80:81], v[68:69] op_sel:[0,0] op_sel_hi:[0,1]
    v_pk_mul_f32 v[86:87], v[80:81], v[70:71] op_sel:[0,0] op_sel_hi:[0,1]
    v_pk_mul_f32 v[88:89], v[80:81], v[72:73] op_sel:[0,0] op_sel_hi:[0,1]
    v_cvt_pk_f16_f32 v216, v72, -v73
    ds_write_addtid_b32 v216 offset:1088
    v_pk_mul_f32 v[90:91], v[80:81], v[74:75] op_sel:[0,0] op_sel_hi:[0,1]
    v_pk_mul_f32 v[92:93], v[80:81], v[76:77] op_sel:[0,0] op_sel_hi:[0,1]
    v_pk_mul_f32 v[94:95], v[80:81], v[78:79] op_sel:[0,0] op_sel_hi:[0,1]
    v_cvt_pk_f16_f32 v217, v132, v133
    ds_write_addtid_b32 v217 offset:9248
    v_pk_mul_f32 v[96:97], v[80:81], v[80:81] op_sel:[0,0] op_sel_hi:[0,1]
    v_pk_fma_f32 v[82:83], v[80:81], v[66:67], v[82:83] op_sel:[1,1,0] op_sel_hi:[1,0,1] neg_lo:[1,0,0]
    v_pk_fma_f32 v[84:85], v[80:81], v[68:69], v[84:85] op_sel:[1,1,0] op_sel_hi:[1,0,1] neg_lo:[1,0,0]
    v_cvt_pk_f16_f32 v218, v134, v135
    ds_write_addtid_b32 v218 offset:9520
    v_pk_fma_f32 v[86:87], v[80:81], v[70:71], v[86:87] op_sel:[1,1,0] op_sel_hi:[1,0,1] neg_lo:[1,0,0]
    v_pk_fma_f32 v[88:89], v[80:81], v[72:73], v[88:89] op_sel:[1,1,0] op_sel_hi:[1,0,1] neg_lo:[1,0,0]
    v_pk_fma_f32 v[90:91], v[80:81], v[74:75], v[90:91] op_sel:[1,1,0] op_sel_hi:[1,0,1] neg_lo:[1,0,0]
    v_pk_fma_f32 v[92:93], v[80:81], v[76:77], v[92:93] op_sel:[1,1,0] op_sel_hi:[1,0,1] neg_lo:[1,0,0]
    v_pk_fma_f32 v[94:95], v[80:81], v[78:79], v[94:95] op_sel:[1,1,0] op_sel_hi:[1,0,1] neg_lo:[1,0,0]
    v_pk_fma_f32 v[96:97], v[80:81], v[80:81], v[96:97] op_sel:[1,1,0] op_sel_hi:[1,0,1] neg_lo:[1,0,0]
    v_pk_mul_f32 v[186:187], v[184:185], v[178:179] op_sel:[0,0] op_sel_hi:[0,1]
    v_cvt_pk_f16_f32 v219, v74, -v75
    ds_write_addtid_b32 v219 offset:1360
    v_pk_mul_f32 v[188:189], v[184:185], v[180:181] op_sel:[0,0] op_sel_hi:[0,1]
    v_pk_mul_f32 v[190:191], v[184:185], v[182:183] op_sel:[0,0] op_sel_hi:[0,1]
    v_pk_mul_f32 v[192:193], v[184:185], v[184:185] op_sel:[0,0] op_sel_hi:[0,1]
    v_cvt_pk_f16_f32 v220, v76, -v77
    ds_write_addtid_b32 v220 offset:1632
    v_pk_mul_f32 v[144:145], v[128:129], v[178:179] op_sel:[0,0] op_sel_hi:[0,1]
    v_pk_mul_f32 v[146:147], v[132:133], v[178:179] op_sel:[0,0] op_sel_hi:[0,1]
    v_pk_mul_f32 v[148:149], v[136:137], v[178:179] op_sel:[0,0] op_sel_hi:[0,1]
    v_cvt_pk_f16_f32 v221, v78, -v79
    ds_write_addtid_b32 v221 offset:1904
    v_pk_mul_f32 v[150:151], v[140:141], v[178:179] op_sel:[0,0] op_sel_hi:[0,1]
    v_pk_fma_f32 v[186:187], v[184:185], v[178:179], v[186:187] op_sel:[1,1,0] op_sel_hi:[1,0,1] neg_lo:[1,0,0]
    v_pk_fma_f32 v[188:189], v[184:185], v[180:181], v[188:189] op_sel:[1,1,0] op_sel_hi:[1,0,1] neg_lo:[1,0,0]
    v_cvt_pk_f16_f32 v210, v80, -v81
    ds_write_addtid_b32 v210 offset:2176
    v_pk_fma_f32 v[190:191], v[184:185], v[182:183], v[190:191] op_sel:[1,1,0] op_sel_hi:[1,0,1] neg_lo:[1,0,0]
    v_pk_fma_f32 v[192:193], v[184:185], v[184:185], v[192:193] op_sel:[1,1,0] op_sel_hi:[1,0,1] neg_lo:[1,0,0]
    v_pk_fma_f32 v[144:145], v[128:129], v[178:179], v[144:145] op_sel:[1,1,0] op_sel_hi:[1,0,1] neg_lo:[1,0,0]
    v_cvt_pk_f16_f32 v211, v136, v137
    ds_write_addtid_b32 v211 offset:9792
    v_pk_fma_f32 v[146:147], v[132:133], v[178:179], v[146:147] op_sel:[1,1,0] op_sel_hi:[1,0,1] neg_lo:[1,0,0]
    v_pk_fma_f32 v[148:149], v[136:137], v[178:179], v[148:149] op_sel:[1,1,0] op_sel_hi:[1,0,1] neg_lo:[1,0,0]
    v_pk_fma_f32 v[150:151], v[140:141], v[178:179], v[150:151] op_sel:[1,1,0] op_sel_hi:[1,0,1] neg_lo:[1,0,0]
    v_cvt_pk_f16_f32 v212, v138, v139
    ds_write_addtid_b32 v212 offset:10064
    v_pk_mul_f32 v[98:99], v[96:97], v[66:67] op_sel:[0,0] op_sel_hi:[0,1]
    v_pk_mul_f32 v[100:101], v[96:97], v[68:69] op_sel:[0,0] op_sel_hi:[0,1]
    v_pk_mul_f32 v[102:103], v[96:97], v[70:71] op_sel:[0,0] op_sel_hi:[0,1]
    v_cvt_pk_f16_f32 v213, v140, v141
    ds_write_addtid_b32 v213 offset:10336
    v_pk_mul_f32 v[104:105], v[96:97], v[72:73] op_sel:[0,0] op_sel_hi:[0,1]
    v_pk_mul_f32 v[106:107], v[96:97], v[74:75] op_sel:[0,0] op_sel_hi:[0,1]
    v_pk_mul_f32 v[108:109], v[96:97], v[76:77] op_sel:[0,0] op_sel_hi:[0,1]
    v_cvt_pk_f16_f32 v214, v142, v143
    ds_write_addtid_b32 v214 offset:10608
    v_pk_mul_f32 v[110:111], v[96:97], v[78:79] op_sel:[0,0] op_sel_hi:[0,1]
    v_pk_mul_f32 v[112:113], v[96:97], v[80:81] op_sel:[0,0] op_sel_hi:[0,1]
    v_pk_fma_f32 v[98:99], v[96:97], v[66:67], v[98:99] op_sel:[1,1,0] op_sel_hi:[1,0,1] neg_lo:[1,0,0]
    v_cvt_pk_f16_f32 v215, v82, -v83
    ds_write_addtid_b32 v215 offset:2448
    v_pk_fma_f32 v[100:101], v[96:97], v[68:69], v[100:101] op_sel:[1,1,0] op_sel_hi:[1,0,1] neg_lo:[1,0,0]
    v_pk_fma_f32 v[102:103], v[96:97], v[70:71], v[102:103] op_sel:[1,1,0] op_sel_hi:[1,0,1] neg_lo:[1,0,0]
    v_pk_fma_f32 v[104:105], v[96:97], v[72:73], v[104:105] op_sel:[1,1,0] op_sel_hi:[1,0,1] neg_lo:[1,0,0]
    v_cvt_pk_f16_f32 v216, v84, -v85
    ds_write_addtid_b32 v216 offset:2720
    v_pk_fma_f32 v[106:107], v[96:97], v[74:75], v[106:107] op_sel:[1,1,0] op_sel_hi:[1,0,1] neg_lo:[1,0,0]
    v_pk_fma_f32 v[108:109], v[96:97], v[76:77], v[108:109] op_sel:[1,1,0] op_sel_hi:[1,0,1] neg_lo:[1,0,0]
    v_pk_fma_f32 v[110:111], v[96:97], v[78:79], v[110:111] op_sel:[1,1,0] op_sel_hi:[1,0,1] neg_lo:[1,0,0]
    v_cvt_pk_f16_f32 v217, v86, -v87
    ds_write_addtid_b32 v217 offset:2992
    v_pk_fma_f32 v[112:113], v[96:97], v[80:81], v[112:113] op_sel:[1,1,0] op_sel_hi:[1,0,1] neg_lo:[1,0,0]
    v_pk_mul_f32 v[152:153], v[128:129], v[180:181] op_sel:[0,0] op_sel_hi:[0,1]
    v_pk_mul_f32 v[154:155], v[136:137], v[180:181] op_sel:[0,0] op_sel_hi:[0,1]
    v_cvt_pk_f16_f32 v218, v88, -v89
    ds_write_addtid_b32 v218 offset:3264
    v_pk_mul_f32 v[156:157], v[128:129], v[182:183] op_sel:[0,0] op_sel_hi:[0,1]
    v_pk_mul_f32 v[158:159], v[136:137], v[182:183] op_sel:[0,0] op_sel_hi:[0,1]
    v_pk_mul_f32 v[160:161], v[128:129], v[184:185] op_sel:[0,0] op_sel_hi:[0,1]
    v_cvt_pk_f16_f32 v219, v90, -v91
    ds_write_addtid_b32 v219 offset:3536
    v_pk_mul_f32 v[162:163], v[128:129], v[186:187] op_sel:[0,0] op_sel_hi:[0,1]
    v_pk_mul_f32 v[164:165], v[128:129], v[188:189] op_sel:[0,0] op_sel_hi:[0,1]
    v_pk_mul_f32 v[166:167], v[128:129], v[190:191] op_sel:[0,0] op_sel_hi:[0,1]
    v_cvt_pk_f16_f32 v220, v92, -v93
    ds_write_addtid_b32 v220 offset:3808
    v_pk_mul_f32 v[168:169], v[128:129], v[192:193] op_sel:[0,0] op_sel_hi:[0,1]
    v_pk_fma_f32 v[152:153], v[128:129], v[180:181], v[152:153] op_sel:[1,1,0] op_sel_hi:[1,0,1] neg_lo:[1,0,0]
    v_pk_fma_f32 v[154:155], v[136:137], v[180:181], v[154:155] op_sel:[1,1,0] op_sel_hi:[1,0,1] neg_lo:[1,0,0]
    v_cvt_pk_f16_f32 v221, v94, -v95
    ds_write_addtid_b32 v221 offset:4080
    v_pk_fma_f32 v[156:157], v[128:129], v[182:183], v[156:157] op_sel:[1,1,0] op_sel_hi:[1,0,1] neg_lo:[1,0,0]
    v_pk_fma_f32 v[158:159], v[136:137], v[182:183], v[158:159] op_sel:[1,1,0] op_sel_hi:[1,0,1] neg_lo:[1,0,0]
    v_pk_fma_f32 v[160:161], v[128:129], v[184:185], v[160:161] op_sel:[1,1,0] op_sel_hi:[1,0,1] neg_lo:[1,0,0]
    v_cvt_pk_f16_f32 v210, v96, -v97
    ds_write_addtid_b32 v210 offset:4352
    v_pk_fma_f32 v[162:163], v[128:129], v[186:187], v[162:163] op_sel:[1,1,0] op_sel_hi:[1,0,1] neg_lo:[1,0,0]
    v_pk_fma_f32 v[164:165], v[128:129], v[188:189], v[164:165] op_sel:[1,1,0] op_sel_hi:[1,0,1] neg_lo:[1,0,0]
    v_pk_fma_f32 v[166:167], v[128:129], v[190:191], v[166:167] op_sel:[1,1,0] op_sel_hi:[1,0,1] neg_lo:[1,0,0]
    v_cvt_pk_f16_f32 v211, v144, v145
    ds_write_addtid_b32 v211 offset:10880
    v_pk_fma_f32 v[168:169], v[128:129], v[192:193], v[168:169] op_sel:[1,1,0] op_sel_hi:[1,0,1] neg_lo:[1,0,0]
    v_pk_mul_f32 v[114:115], v[96:97], v[82:83] op_sel:[0,0] op_sel_hi:[0,1]
    v_pk_mul_f32 v[116:117], v[96:97], v[84:85] op_sel:[0,0] op_sel_hi:[0,1]
    s_mul_i32 s89, s39, 22528
    s_add_u32 s89, s89, 69632
    s_mov_b32 m0, s89
    s_add_u32 s89, s89, 2048
    buffer_load_dwordx4 v16, s[52:55], s90 offen lds
    buffer_load_dwordx4 v19, s[52:55], s90 offen offset:1024 lds
    s_add_u32 s90, s90, 16384
    s_cmp_ge_u32 s90, 458752
    s_cselect_b32 s91, 458752, 0
    s_sub_u32 s90, s90, s91
    s_mov_b32 m0, s80
    v_cvt_pk_f16_f32 v212, v146, v147
    ds_write_addtid_b32 v212 offset:11152
    v_pk_mul_f32 v[118:119], v[96:97], v[86:87] op_sel:[0,0] op_sel_hi:[0,1]
    v_pk_mul_f32 v[120:121], v[96:97], v[88:89] op_sel:[0,0] op_sel_hi:[0,1]
    v_pk_mul_f32 v[122:123], v[96:97], v[90:91] op_sel:[0,0] op_sel_hi:[0,1]
    v_cvt_pk_f16_f32 v213, v148, v149
    ds_write_addtid_b32 v213 offset:11424
    v_pk_mul_f32 v[124:125], v[96:97], v[92:93] op_sel:[0,0] op_sel_hi:[0,1]
    v_pk_mul_f32 v[126:127], v[96:97], v[94:95] op_sel:[0,0] op_sel_hi:[0,1]
    v_pk_fma_f32 v[114:115], v[96:97], v[82:83], v[114:115] op_sel:[1,1,0] op_sel_hi:[1,0,1] neg_lo:[1,0,0]
    v_cvt_pk_f16_f32 v214, v150, v151
    ds_write_addtid_b32 v214 offset:11696
    v_pk_fma_f32 v[116:117], v[96:97], v[84:85], v[116:117] op_sel:[1,1,0] op_sel_hi:[1,0,1] neg_lo:[1,0,0]
    v_pk_fma_f32 v[118:119], v[96:97], v[86:87], v[118:119] op_sel:[1,1,0] op_sel_hi:[1,0,1] neg_lo:[1,0,0]
    v_pk_fma_f32 v[120:121], v[96:97], v[88:89], v[120:121] op_sel:[1,1,0] op_sel_hi:[1,0,1] neg_lo:[1,0,0]
    v_cvt_pk_f16_f32 v215, v98, -v99
    ds_write_addtid_b32 v215 offset:4624
    v_pk_fma_f32 v[122:123], v[96:97], v[90:91], v[122:123] op_sel:[1,1,0] op_sel_hi:[1,0,1] neg_lo:[1,0,0]
    v_pk_fma_f32 v[124:125], v[96:97], v[92:93], v[124:125] op_sel:[1,1,0] op_sel_hi:[1,0,1] neg_lo:[1,0,0]
    v_pk_fma_f32 v[126:127], v[96:97], v[94:95], v[126:127] op_sel:[1,1,0] op_sel_hi:[1,0,1] neg_lo:[1,0,0]
    v_cvt_pk_f16_f32 v216, v100, -v101
    ds_write_addtid_b32 v216 offset:4896
    s_mov_b32 m0, s89
    s_add_u32 s89, s89, 2048
    buffer_load_dwordx4 v16, s[52:55], s90 offen lds
    buffer_load_dwordx4 v19, s[52:55], s90 offen offset:1024 lds
    s_add_u32 s90, s90, 16384
    s_cmp_ge_u32 s90, 458752
    s_cselect_b32 s91, 458752, 0
    s_sub_u32 s90, s90, s91
    s_mov_b32 m0, s80
    v_cvt_pk_f16_f32 v217, v102, -v103
    ds_write_addtid_b32 v217 offset:5168
    v_cvt_pk_f16_f32 v218, v104, -v105
    ds_write_addtid_b32 v218 offset:5440
    v_cvt_pk_f16_f32 v219, v106, -v107
    ds_write_addtid_b32 v219 offset:5712
    v_cvt_pk_f16_f32 v220, v108, -v109
    ds_write_addtid_b32 v220 offset:5984
    v_cvt_pk_f16_f32 v221, v110, -v111
    ds_write_addtid_b32 v221 offset:6256
    v_cvt_pk_f16_f32 v210, v112, -v113
    ds_write_addtid_b32 v210 offset:6528
    v_cvt_pk_f16_f32 v211, v152, v153
    ds_write_addtid_b32 v211 offset:11968
    v_cvt_pk_f16_f32 v212, v154, v155
    ds_write_addtid_b32 v212 offset:12240
    v_cvt_pk_f16_f32 v213, v156, v157
    ds_write_addtid_b32 v213 offset:12512
    v_cvt_pk_f16_f32 v214, v158, v159
    ds_write_addtid_b32 v214 offset:12784
    v_cvt_pk_f16_f32 v215, v160, v161
    ds_write_addtid_b32 v215 offset:13056
    s_mov_b32 m0, s89
    s_add_u32 s89, s89, 2048
    buffer_load_dwordx4 v16, s[52:55], s90 offen lds
    buffer_load_dwordx4 v19, s[52:55], s90 offen offset:1024 lds
    s_add_u32 s90, s90, 16384
    s_cmp_ge_u32 s90, 458752
    s_cselect_b32 s91, 458752, 0
    s_sub_u32 s90, s90, s91
    s_mov_b32 m0, s80
    v_cvt_pk_f16_f32 v216, v162, v163
    ds_write_addtid_b32 v216 offset:13328
    v_cvt_pk_f16_f32 v217, v164, v165
    ds_write_addtid_b32 v217 offset:13600
    v_cvt_pk_f16_f32 v218, v166, v167
    ds_write_addtid_b32 v218 offset:13872
    v_cvt_pk_f16_f32 v219, v168, v169
    ds_write_addtid_b32 v219 offset:14144
    v_cvt_pk_f16_f32 v220, v114, -v115
    ds_write_addtid_b32 v220 offset:6800
    v_cvt_pk_f16_f32 v221, v116, -v117
    ds_write_addtid_b32 v221 offset:7072
    v_cvt_pk_f16_f32 v210, v118, -v119
    ds_write_addtid_b32 v210 offset:7344
    v_cvt_pk_f16_f32 v211, v120, -v121
    ds_write_addtid_b32 v211 offset:7616
    v_cvt_pk_f16_f32 v212, v122, -v123
    ds_write_addtid_b32 v212 offset:7888
    v_cvt_pk_f16_f32 v213, v124, -v125
    ds_write_addtid_b32 v213 offset:8160
    v_cvt_pk_f16_f32 v214, v126, -v127
    ds_write_addtid_b32 v214 offset:8432
    s_mov_b32 m0, s89
    s_add_u32 s89, s89, 2048
    buffer_load_dwordx4 v16, s[52:55], s90 offen lds
    buffer_load_dwordx4 v19, s[52:55], s90 offen offset:1024 lds
    s_add_u32 s90, s90, 16384
    s_cmp_ge_u32 s90, 458752
    s_cselect_b32 s91, 458752, 0
    s_sub_u32 s90, s90, s91
    s_mov_b32 m0, s80
    v_and_b32 v54, 31, v1
    v_mul_u32_u24 v54, 272, v54
    v_lshrrev_b32 v55, 5, v1
    v_lshlrev_b32 v55, 4, v55
    v_add3_u32 v54, v54, v55, s80
    s_waitcnt lgkmcnt(0)
    ds_read_b128 v[64:67], v54 offset:8704
    ds_read_b128 v[68:71], v54 offset:0
    ds_read_b128 v[72:75], v54 offset:8736
    ds_read_b128 v[76:79], v54 offset:32
    ds_read_b128 v[80:83], v54 offset:8768
    ds_read_b128 v[84:87], v54 offset:64
    ds_read_b128 v[88:91], v54 offset:8800
    ds_read_b128 v[92:95], v54 offset:96
    ds_read_b128 v[96:99], v54 offset:8832
    ds_read_b128 v[100:103], v54 offset:128
    ds_read_b128 v[104:107], v54 offset:8864
    ds_read_b128 v[108:111], v54 offset:160
    ds_read_b128 v[112:115], v54 offset:8896
    ds_read_b128 v[116:119], v54 offset:192
    ds_read_b128 v[120:123], v54 offset:8928
    ds_read_b128 v[124:127], v54 offset:224
    v_and_b32 v56, 31, v1
    v_lshlrev_b32 v56, 2, v56
    v_lshlrev_b32 v57, 7, v55
    s_lshl_b32 s65, s39, 7
    s_add_u32 s65, s65, 57664
    v_add3_u32 v56, v56, v57, s65
    s_waitcnt lgkmcnt(14)
    v_mfma_f32_32x32x16_f16 v[128:143], v[64:67], v[68:71], 0
    s_waitcnt lgkmcnt(12)
    v_mfma_f32_32x32x16_f16 v[128:143], v[72:75], v[76:79], v[128:143]
    s_waitcnt lgkmcnt(10)
    v_mfma_f32_32x32x16_f16 v[128:143], v[80:83], v[84:87], v[128:143]
    s_waitcnt lgkmcnt(8)
    v_mfma_f32_32x32x16_f16 v[128:143], v[88:91], v[92:95], v[128:143]
    s_waitcnt lgkmcnt(6)
    v_mfma_f32_32x32x16_f16 v[128:143], v[96:99], v[100:103], v[128:143]
    s_waitcnt lgkmcnt(4)
    v_mfma_f32_32x32x16_f16 v[128:143], v[104:107], v[108:111], v[128:143]
    s_waitcnt lgkmcnt(2)
    v_mfma_f32_32x32x16_f16 v[128:143], v[112:115], v[116:119], v[128:143]
    s_waitcnt lgkmcnt(0)
    v_mfma_f32_32x32x16_f16 v[128:143], v[120:123], v[124:127], v[128:143]
    s_barrier
    s_nop 10
    v_ldexp_f32 v128, v128, v52
    v_ldexp_f32 v129, v129, v52
    v_ldexp_f32 v130, v130, v52
    v_ldexp_f32 v131, v131, v52
    v_ldexp_f32 v132, v132, v52
    v_ldexp_f32 v133, v133, v52
    v_ldexp_f32 v134, v134, v52
    v_ldexp_f32 v135, v135, v52
    v_ldexp_f32 v136, v136, v52
    v_ldexp_f32 v137, v137, v52
    v_ldexp_f32 v138, v138, v52
    v_ldexp_f32 v139, v139, v52
    ds_write_b32 v56, v128 offset:0
    ds_write_b32 v56, v129 offset:512
    ds_write_b32 v56, v130 offset:1024
    ds_write_b32 v56, v131 offset:1536
    ds_write_b32 v56, v132 offset:4096
    ds_write_b32 v56, v133 offset:4608
    ds_write_b32 v56, v134 offset:5120
    ds_write_b32 v56, v135 offset:5632
    ds_write_b32 v56, v136 offset:8192
    s_mov_b32 exec_hi, 0
    ds_write_b32 v56, v137 offset:8704
    ds_write_b32 v56, v138 offset:9216
    ds_write_b32 v56, v139 offset:9728
    s_mov_b32 exec_hi, -1
    s_waitcnt vmcnt(14)
    v_and_b32 v64, 0xffff, v28
    v_add_u32 v64, 57664, v64
    v_lshrrev_b32 v65, 16, v28
    v_add_u32 v65, 57664, v65
    v_and_b32 v66, 0xffff, v29
    v_add_u32 v66, 57664, v66
    v_lshrrev_b32 v67, 16, v29
    v_add_u32 v67, 57664, v67
    v_and_b32 v68, 0xffff, v30
    v_add_u32 v68, 57664, v68
    v_lshrrev_b32 v69, 16, v30
    v_add_u32 v69, 57664, v69
    v_and_b32 v70, 0xffff, v31
    v_add_u32 v70, 57664, v70
    v_lshrrev_b32 v71, 16, v31
    v_add_u32 v71, 57664, v71
    v_and_b32 v72, 0xffff, v32
    v_add_u32 v72, 57664, v72
    s_waitcnt lgkmcnt(0)
    s_barrier
    v_lshlrev_b32 v192, 4, v0
    v_add_u32 v193, 65536, v192
    s_lshl_b32 s83, s42, 14
    s_add_u32 s83, s83, 12582912
    v_add_u32 v192, s83, v192
    s_mov_b32 s84, 4096
    s_mov_b32 s85, 8192
    s_mov_b32 s92, 12288
    buffer_load_dwordx4 v[160:163], v192, s[44:47], 0 offen sc1
    buffer_load_dwordx4 v[164:167], v192, s[44:47], s84 offen sc1
    buffer_load_dwordx4 v[168:171], v192, s[44:47], s85 offen sc1
    buffer_load_dwordx4 v[172:175], v192, s[44:47], s92 offen sc1
    buffer_load_dwordx4 v[176:179], v193, s[44:47], 0 offen sc1
    buffer_load_dwordx4 v[180:183], v193, s[44:47], s84 offen sc1
    buffer_load_dwordx4 v[184:187], v193, s[44:47], s85 offen sc1
    buffer_load_dwordx4 v[188:191], v193, s[44:47], s92 offen sc1
    ds_read2_b32 v[76:77], v64 offset0:0 offset1:32
    ds_read2_b32 v[78:79], v64 offset0:64 offset1:96
    ds_read2_b32 v[80:81], v65 offset0:0 offset1:32
    ds_read2_b32 v[82:83], v65 offset0:64 offset1:96
    ds_read2_b32 v[84:85], v66 offset0:0 offset1:32
    ds_read2_b32 v[86:87], v66 offset0:64 offset1:96
    ds_read2_b32 v[88:89], v67 offset0:0 offset1:32
    ds_read2_b32 v[90:91], v67 offset0:64 offset1:96
    ds_read2_b32 v[92:93], v68 offset0:0 offset1:32
    ds_read2_b32 v[94:95], v68 offset0:64 offset1:96
    ds_read2_b32 v[96:97], v69 offset0:0 offset1:32
    ds_read2_b32 v[98:99], v69 offset0:64 offset1:96
    ds_read2_b32 v[100:101], v70 offset0:0 offset1:32
    ds_read2_b32 v[102:103], v70 offset0:64 offset1:96
    ds_read2_b32 v[104:105], v71 offset0:0 offset1:32
    ds_read2_b32 v[106:107], v71 offset0:64 offset1:96
    ds_read2_b32 v[108:109], v72 offset0:0 offset1:32
    ds_read2_b32 v[110:111], v72 offset0:64 offset1:96
    v_mov_b32 v36, 0
    v_mov_b32 v37, 0
    v_mov_b32 v38, 0
    v_mov_b32 v39, 0
    v_and_b32 v59, 1, v0
    v_lshlrev_b32 v59, 4, v59
    v_lshrrev_b32 v60, 1, v0
    v_mul_u32_u24 v60, 4160, v60
    v_add_u32 v59, v59, v60
    v_and_b32 v61, 15, v0
    v_lshlrev_b32 v61, 4, v61
    v_lshrrev_b32 v60, 4, v0
    v_mul_u32_u24 v60, 2368, v60
    v_add_u32 v61, v61, v60
    v_lshlrev_b32 v58, 4, v0
    s_mov_b32 s81, 0x05040100
    s_mov_b32 s82, 0x07060302
    s_waitcnt lgkmcnt(15)
    v_add_f32 v76, v76, v77
    v_add_f32 v78, v78, v79
    v_cvt_pk_bf16_f32 v112, v76, v78
    s_waitcnt lgkmcnt(14)
    v_add_f32 v80, v80, v81
    v_add_f32 v82, v82, v83
    v_cvt_pk_bf16_f32 v113, v80, v82
    s_waitcnt lgkmcnt(12)
    v_add_f32 v84, v84, v85
    v_add_f32 v86, v86, v87
    v_cvt_pk_bf16_f32 v114, v84, v86
    s_waitcnt lgkmcnt(10)
    v_add_f32 v88, v88, v89
    v_add_f32 v90, v90, v91
    v_cvt_pk_bf16_f32 v115, v88, v90
    s_waitcnt lgkmcnt(8)
    v_add_f32 v92, v92, v93
    v_add_f32 v94, v94, v95
    v_cvt_pk_bf16_f32 v116, v92, v94
    s_waitcnt lgkmcnt(6)
    v_add_f32 v96, v96, v97
    v_add_f32 v98, v98, v99
    v_cvt_pk_bf16_f32 v117, v96, v98
    s_waitcnt lgkmcnt(4)
    v_add_f32 v100, v100, v101
    v_add_f32 v102, v102, v103
    v_cvt_pk_bf16_f32 v118, v100, v102
    s_waitcnt lgkmcnt(2)
    v_add_f32 v104, v104, v105
    v_add_f32 v106, v106, v107
    v_cvt_pk_bf16_f32 v119, v104, v106
    s_waitcnt lgkmcnt(0)
    v_add_f32 v108, v108, v109
    v_add_f32 v110, v110, v111
    v_cvt_pk_bf16_f32 v120, v108, v110
    v_perm_b32 v124, v114, v113, s81
    v_perm_b32 v128, v113, v112, s81
    v_perm_b32 v125, v116, v115, s81
    v_perm_b32 v129, v115, v114, s81
    v_perm_b32 v126, v118, v117, s81
    v_perm_b32 v130, v117, v116, s81
    v_perm_b32 v127, v120, v119, s81
    v_perm_b32 v131, v119, v118, s81
    ds_write_b128 v58, v[124:127] offset:32
    ds_write_b128 v58, v[128:131] offset:4192
    v_perm_b32 v132, v114, v113, s82
    v_perm_b32 v136, v113, v112, s82
    v_perm_b32 v133, v116, v115, s82
    v_perm_b32 v137, v115, v114, s82
    v_perm_b32 v134, v118, v117, s82
    v_perm_b32 v138, v117, v116, s82
    v_perm_b32 v135, v120, v119, s82
    v_perm_b32 v139, v119, v118, s82
    ds_write_b128 v58, v[132:135] offset:8352
    ds_write_b128 v58, v[136:139] offset:12512
    v_cmp_gt_u32 vcc, 8, v0
    s_nop 0
    s_and_saveexec_b64 s[72:73], vcc
    ds_write_b128 v59, v[36:39] offset:0
    s_mov_b64 exec, s[72:73]
    v_cmp_gt_u32 vcc, 64, v0
    s_nop 0
    s_and_saveexec_b64 s[72:73], vcc
    ds_write_b128 v61, v[36:39] offset:16896
    s_mov_b64 exec, s[72:73]
    s_mov_b32 s83, 0
    s_branch L_pollst_first_3
L_pollst_1:
    s_mov_b64 exec, vcc
    buffer_load_dwordx4 v[160:163], v192, s[44:47], 0 offen sc1
    buffer_load_dwordx4 v[164:167], v192, s[44:47], s84 offen sc1
    buffer_load_dwordx4 v[168:171], v192, s[44:47], s85 offen sc1
    buffer_load_dwordx4 v[172:175], v192, s[44:47], s92 offen sc1
    buffer_load_dwordx4 v[176:179], v193, s[44:47], 0 offen sc1
    buffer_load_dwordx4 v[180:183], v193, s[44:47], s84 offen sc1
    buffer_load_dwordx4 v[184:187], v193, s[44:47], s85 offen sc1
    buffer_load_dwordx4 v[188:191], v193, s[44:47], s92 offen sc1
    s_mov_b64 exec, -1
L_pollst_first_3:
    s_waitcnt vmcnt(0)
    v_xor_b32 v61, s38, v177
    v_xor_b32 v62, s38, v179
    v_xor_b32 v59, s38, v163
    v_or3_b32 v61, v61, v62, v59
    v_xor_b32 v62, s38, v181
    v_xor_b32 v59, s38, v165
    v_or3_b32 v61, v61, v62, v59
    v_xor_b32 v62, s38, v183
    v_xor_b32 v59, s38, v167
    v_or3_b32 v61, v61, v62, v59
    v_xor_b32 v62, s38, v185
    v_xor_b32 v59, s38, v169
    v_or3_b32 v61, v61, v62, v59
    v_xor_b32 v62, s38, v187
    v_xor_b32 v59, s38, v171
    v_or3_b32 v61, v61, v62, v59
    v_xor_b32 v62, s38, v189
    v_xor_b32 v59, s38, v173
    v_or3_b32 v61, v61, v62, v59
    v_xor_b32 v62, s38, v191
    v_xor_b32 v59, s38, v175
    v_or3_b32 v61, v61, v62, v59
    v_xor_b32 v62, s38, v161
    v_or_b32 v61, v61, v62
    v_cmp_ne_u32 vcc, 0, v61
    s_add_u32 s83, s83, 1
    s_cmp_ge_u32 s83, 65536
    s_cbranch_scc1 L_pollst_done_2
    s_cbranch_vccnz L_pollst_1
L_pollst_done_2:
    s_mul_i32 s91, s39, 22528
    s_add_u32 s91, s91, 69632
    v_add_u32 v30, s91, v17
    v_add_u32 v31, s91, v18
    ds_read_b64_tr_b16 a[0:1], v30 offset:0
    ds_read_b64_tr_b16 a[2:3], v30 offset:1024
    ds_read_b64_tr_b16 a[112:113], v31 offset:0
    ds_read_b64_tr_b16 a[114:115], v31 offset:1024
    ds_read_b64_tr_b16 a[4:5], v30 offset:2048
    ds_read_b64_tr_b16 a[6:7], v30 offset:3072
    ds_read_b64_tr_b16 a[116:117], v31 offset:2048
    ds_read_b64_tr_b16 a[118:119], v31 offset:3072
    ds_read_b64_tr_b16 a[8:9], v30 offset:4096
    ds_read_b64_tr_b16 a[10:11], v30 offset:5120
    ds_read_b64_tr_b16 a[120:121], v31 offset:4096
    ds_read_b64_tr_b16 a[122:123], v31 offset:5120
    ds_read_b64_tr_b16 a[12:13], v30 offset:6144
    ds_read_b64_tr_b16 a[14:15], v30 offset:7168
    ds_read_b64_tr_b16 a[124:125], v31 offset:6144
    ds_read_b64_tr_b16 a[126:127], v31 offset:7168
    s_lshl_b32 s84, s62, 16
    s_and_b32 s85, s62, 0xffff0000
    v_and_b32 v88, 0xffff0000, v176
    v_lshlrev_b32 v80, 16, v176
    v_rcp_f32 v88, v88
    v_and_b32 v89, 0xffff0000, v178
    v_lshlrev_b32 v81, 16, v178
    v_rcp_f32 v89, v89
    v_and_b32 v90, 0xffff0000, v180
    v_lshlrev_b32 v82, 16, v180
    v_rcp_f32 v90, v90
    v_and_b32 v91, 0xffff0000, v182
    v_lshlrev_b32 v83, 16, v182
    v_rcp_f32 v91, v91
    v_and_b32 v92, 0xffff0000, v184
    v_lshlrev_b32 v84, 16, v184
    v_rcp_f32 v92, v92
    v_and_b32 v93, 0xffff0000, v186
    v_lshlrev_b32 v85, 16, v186
    v_rcp_f32 v93, v93
    v_and_b32 v94, 0xffff0000, v188
    v_lshlrev_b32 v86, 16, v188
    v_rcp_f32 v94, v94
    v_and_b32 v95, 0xffff0000, v190
    v_lshlrev_b32 v87, 16, v190
    v_rcp_f32 v95, v95
    v_lshlrev_b32 v128, 16, v160
    v_and_b32 v129, 0xffff0000, v160
    v_lshlrev_b32 v130, 16, v162
    v_and_b32 v131, 0xffff0000, v162
    v_lshlrev_b32 v132, 16, v164
    v_and_b32 v133, 0xffff0000, v164
    v_lshlrev_b32 v134, 16, v166
    v_and_b32 v135, 0xffff0000, v166
    v_lshlrev_b32 v136, 16, v168
    v_and_b32 v137, 0xffff0000, v168
    v_lshlrev_b32 v138, 16, v170
    v_and_b32 v139, 0xffff0000, v170
    v_lshlrev_b32 v140, 16, v172
    v_and_b32 v141, 0xffff0000, v172
    v_lshlrev_b32 v142, 16, v174
    v_and_b32 v143, 0xffff0000, v174
    v_pk_add_f32 v[96:97], v[128:129], v[80:81] op_sel:[0,0] op_sel_hi:[1,0] neg_lo:[0,1] neg_hi:[0,1]
    v_pk_add_f32 v[98:99], v[130:131], v[80:81] op_sel:[0,1] op_sel_hi:[1,1] neg_lo:[0,1] neg_hi:[0,1]
    v_pk_add_f32 v[100:101], v[132:133], v[82:83] op_sel:[0,0] op_sel_hi:[1,0] neg_lo:[0,1] neg_hi:[0,1]
    v_pk_add_f32 v[102:103], v[134:135], v[82:83] op_sel:[0,1] op_sel_hi:[1,1] neg_lo:[0,1] neg_hi:[0,1]
    v_pk_add_f32 v[104:105], v[136:137], v[84:85] op_sel:[0,0] op_sel_hi:[1,0] neg_lo:[0,1] neg_hi:[0,1]
    v_pk_add_f32 v[106:107], v[138:139], v[84:85] op_sel:[0,1] op_sel_hi:[1,1] neg_lo:[0,1] neg_hi:[0,1]
    v_pk_add_f32 v[108:109], v[140:141], v[86:87] op_sel:[0,0] op_sel_hi:[1,0] neg_lo:[0,1] neg_hi:[0,1]
    v_pk_add_f32 v[110:111], v[142:143], v[86:87] op_sel:[0,1] op_sel_hi:[1,1] neg_lo:[0,1] neg_hi:[0,1]
    v_cvt_pk_bf16_f32 v112, v96, v97
    v_cvt_pk_bf16_f32 v113, v98, v99
    v_cvt_pk_bf16_f32 v114, v100, v101
    v_cvt_pk_bf16_f32 v115, v102, v103
    v_cvt_pk_bf16_f32 v116, v104, v105
    v_cvt_pk_bf16_f32 v117, v106, v107
    v_cvt_pk_bf16_f32 v118, v108, v109
    v_cvt_pk_bf16_f32 v119, v110, v111
    v_lshlrev_b32 v96, 16, v112
    v_and_b32 v97, 0xffff0000, v112
    v_lshlrev_b32 v98, 16, v113
    v_and_b32 v99, 0xffff0000, v113
    v_lshlrev_b32 v100, 16, v114
    v_and_b32 v101, 0xffff0000, v114
    v_lshlrev_b32 v102, 16, v115
    v_and_b32 v103, 0xffff0000, v115
    v_lshlrev_b32 v104, 16, v116
    v_and_b32 v105, 0xffff0000, v116
    v_lshlrev_b32 v106, 16, v117
    v_and_b32 v107, 0xffff0000, v117
    v_lshlrev_b32 v108, 16, v118
    v_and_b32 v109, 0xffff0000, v118
    v_lshlrev_b32 v110, 16, v119
    v_and_b32 v111, 0xffff0000, v119
    v_pk_mul_f32 v[96:97], v[96:97], v[88:89] op_sel:[0,0] op_sel_hi:[1,0]
    v_pk_mul_f32 v[98:99], v[98:99], v[88:89] op_sel:[0,1] op_sel_hi:[1,1]
    v_pk_mul_f32 v[100:101], v[100:101], v[90:91] op_sel:[0,0] op_sel_hi:[1,0]
    v_pk_mul_f32 v[102:103], v[102:103], v[90:91] op_sel:[0,1] op_sel_hi:[1,1]
    v_pk_mul_f32 v[104:105], v[104:105], v[92:93] op_sel:[0,0] op_sel_hi:[1,0]
    v_pk_mul_f32 v[106:107], v[106:107], v[92:93] op_sel:[0,1] op_sel_hi:[1,1]
    v_pk_mul_f32 v[108:109], v[108:109], v[94:95] op_sel:[0,0] op_sel_hi:[1,0]
    v_pk_mul_f32 v[110:111], v[110:111], v[94:95] op_sel:[0,1] op_sel_hi:[1,1]
    v_cvt_pk_bf16_f32 v112, v96, v97
    v_cvt_pk_bf16_f32 v113, v98, v99
    v_cvt_pk_bf16_f32 v114, v100, v101
    v_cvt_pk_bf16_f32 v115, v102, v103
    v_cvt_pk_bf16_f32 v116, v104, v105
    v_cvt_pk_bf16_f32 v117, v106, v107
    v_cvt_pk_bf16_f32 v118, v108, v109
    v_cvt_pk_bf16_f32 v119, v110, v111
    s_mov_b32 s81, 0x05040100
    s_mov_b32 s82, 0x07060302
    v_lshrrev_b32 v62, 2, v0
    v_and_b32 v62, 1, v62
    v_mul_u32_u24 v62, 2368, v62
    v_lshrrev_b32 v63, 3, v0
    v_lshlrev_b32 v63, 4, v63
    v_and_b32 v61, 3, v0
    v_xor_b32 v61, 3, v61
    v_lshlrev_b32 v61, 2, v61
    v_add3_u32 v62, v62, v63, v61
    v_perm_b32 v120, v112, v113, s81
    v_perm_b32 v121, v114, v115, s81
    v_perm_b32 v122, v116, v117, s81
    v_perm_b32 v123, v118, v119, s81
    v_perm_b32 v124, v112, v113, s82
    v_perm_b32 v125, v114, v115, s82
    v_perm_b32 v126, v116, v117, s82
    v_perm_b32 v127, v118, v119, s82
    ds_write_b32 v62, v120 offset:17152
    ds_write_b32 v62, v121 offset:17664
    ds_write_b32 v62, v122 offset:18176
    ds_write_b32 v62, v123 offset:18688
    ds_write_b32 v62, v124 offset:21888
    ds_write_b32 v62, v125 offset:22400
    ds_write_b32 v62, v126 offset:22912
    ds_write_b32 v62, v127 offset:23424
    s_waitcnt lgkmcnt(0)
    s_barrier
    ds_read2_b32 v[160:161], v230 offset0:0 offset1:1
    ds_read2_b32 v[162:163], v230 offset0:2 offset1:3
    ds_read_b128 v[192:195], v234 offset:96
    ds_read_b128 v[196:199], v234 offset:352
    ds_read_b128 v[200:203], v234 offset:608
    ds_read_b128 v[204:207], v234 offset:864
    ds_read_b128 v[208:211], v234 offset:1120
    ds_read_b128 v[212:215], v234 offset:1376
    ds_read_b128 v[216:219], v234 offset:1632
    ds_read_b128 v[220:223], v234 offset:1888
    ds_read2_b32 v[164:165], v230 offset0:128 offset1:129
    ds_read2_b32 v[166:167], v230 offset0:130 offset1:131
    ds_read2_b32 v[168:169], v231 offset0:0 offset1:1
    ds_read2_b32 v[170:171], v231 offset0:2 offset1:3
    ds_read2_b32 v[172:173], v231 offset0:128 offset1:129
    ds_read2_b32 v[174:175], v231 offset0:130 offset1:131
    ds_read2_b32 v[176:177], v232 offset0:0 offset1:1
    ds_read2_b32 v[178:179], v232 offset0:2 offset1:3
    ds_read2_b32 v[180:181], v232 offset0:128 offset1:129
    ds_read2_b32 v[182:183], v232 offset0:130 offset1:131
    ds_read2_b32 v[184:185], v233 offset0:0 offset1:1
    ds_read2_b32 v[186:187], v233 offset0:2 offset1:3
    ds_read2_b32 v[188:189], v233 offset0:128 offset1:129
    ds_read2_b32 v[190:191], v233 offset0:130 offset1:131
    v_lshlrev_b32 v144, 16, v112
    v_and_b32 v145, 0xffff0000, v112
    v_lshlrev_b32 v146, 16, v113
    v_and_b32 v147, 0xffff0000, v113
    v_lshlrev_b32 v148, 16, v114
    v_and_b32 v149, 0xffff0000, v114
    v_lshlrev_b32 v150, 16, v115
    v_and_b32 v151, 0xffff0000, v115
    v_lshlrev_b32 v152, 16, v116
    v_and_b32 v153, 0xffff0000, v116
    v_lshlrev_b32 v154, 16, v117
    v_and_b32 v155, 0xffff0000, v117
    v_lshlrev_b32 v156, 16, v118
    v_and_b32 v157, 0xffff0000, v118
    v_lshlrev_b32 v158, 16, v119
    v_and_b32 v159, 0xffff0000, v119
    v_pk_mul_f32 v[144:145], v[144:145], s[84:85]
    v_pk_mul_f32 v[146:147], v[146:147], s[84:85]
    v_pk_mul_f32 v[148:149], v[148:149], s[84:85]
    v_pk_mul_f32 v[150:151], v[150:151], s[84:85]
    v_pk_mul_f32 v[152:153], v[152:153], s[84:85]
    v_pk_mul_f32 v[154:155], v[154:155], s[84:85]
    v_pk_mul_f32 v[156:157], v[156:157], s[84:85]
    v_pk_mul_f32 v[158:159], v[158:159], s[84:85]
    v_cvt_pk_bf16_f32 v20, v144, v145
    v_cvt_pk_bf16_f32 v21, v146, v147
    v_cvt_pk_bf16_f32 v22, v148, v149
    v_cvt_pk_bf16_f32 v23, v150, v151
    v_cvt_pk_bf16_f32 v24, v152, v153
    v_cvt_pk_bf16_f32 v25, v154, v155
    v_cvt_pk_bf16_f32 v26, v156, v157
    v_cvt_pk_bf16_f32 v27, v158, v159
    v_lshlrev_b32 v144, 16, v20
    v_and_b32 v145, 0xffff0000, v20
    v_lshlrev_b32 v146, 16, v21
    v_and_b32 v147, 0xffff0000, v21
    v_lshlrev_b32 v148, 16, v22
    v_and_b32 v149, 0xffff0000, v22
    v_lshlrev_b32 v150, 16, v23
    v_and_b32 v151, 0xffff0000, v23
    v_lshlrev_b32 v152, 16, v24
    v_and_b32 v153, 0xffff0000, v24
    v_lshlrev_b32 v154, 16, v25
    v_and_b32 v155, 0xffff0000, v25
    v_lshlrev_b32 v156, 16, v26
    v_and_b32 v157, 0xffff0000, v26
    v_lshlrev_b32 v158, 16, v27
    v_and_b32 v159, 0xffff0000, v27
    s_waitcnt lgkmcnt(0)
    v_mfma_f32_16x16x32_bf16 v[32:35], v[160:163], v[192:195], 0
    v_mfma_f32_16x16x32_bf16 v[36:39], v[160:163], v[196:199], 0
    ds_read2_b32 v[64:65], v230 offset0:16 offset1:17
    s_mul_i32 s89, s39, 22528
    v_mfma_f32_16x16x32_bf16 v[40:43], v[160:163], v[200:203], 0
    ds_read2_b32 v[66:67], v230 offset0:18 offset1:19
    v_mfma_f32_16x16x32_bf16 v[44:47], v[160:163], v[204:207], 0
    ds_read_b128 v[96:99], v234 offset:64
    s_add_u32 s89, s89, 69632
    v_mfma_f32_16x16x32_bf16 v[48:51], v[160:163], v[208:211], 0
    ds_read_b128 v[100:103], v234 offset:320
    s_mov_b32 m0, s89
    v_mfma_f32_16x16x32_bf16 v[52:55], v[160:163], v[212:215], 0
    v_mfma_f32_16x16x32_bf16 v[56:59], v[160:163], v[216:219], 0
    ds_read_b128 v[104:107], v234 offset:576
    s_add_u32 s89, s89, 2048
    v_mfma_f32_16x16x32_bf16 v[60:63], v[160:163], v[220:223], 0
    ds_read_b128 v[108:111], v234 offset:832
    buffer_load_dwordx4 v16, s[52:55], s90 offen lds
    v_mfma_f32_16x16x32_bf16 v[36:39], v[164:167], v[192:195], v[36:39]
    ds_read_b128 v[112:115], v234 offset:1088
    v_mfma_f32_16x16x32_bf16 v[40:43], v[164:167], v[196:199], v[40:43]
    ds_read_b128 v[116:119], v234 offset:1344
    buffer_load_dwordx4 v19, s[52:55], s90 offen offset:1024 lds
    v_mfma_f32_16x16x32_bf16 v[44:47], v[164:167], v[200:203], v[44:47]
    s_add_u32 s90, s90, 16384
    v_mfma_f32_16x16x32_bf16 v[48:51], v[164:167], v[204:207], v[48:51]
    ds_read_b128 v[120:123], v234 offset:1600
    v_mfma_f32_16x16x32_bf16 v[52:55], v[164:167], v[208:211], v[52:55]
    ds_read_b128 v[124:127], v234 offset:1856
    s_cmp_ge_u32 s90, 458752
    v_mfma_f32_16x16x32_bf16 v[56:59], v[164:167], v[212:215], v[56:59]
    ds_read2_b32 v[68:69], v230 offset0:144 offset1:145
    s_cselect_b32 s91, 458752, 0
    v_mfma_f32_16x16x32_bf16 v[60:63], v[164:167], v[216:219], v[60:63]
    ds_read2_b32 v[70:71], v230 offset0:146 offset1:147
    v_mfma_f32_16x16x32_bf16 v[40:43], v[168:171], v[192:195], v[40:43]
    s_sub_u32 s90, s90, s91
    v_mfma_f32_16x16x32_bf16 v[44:47], v[168:171], v[196:199], v[44:47]
    ds_read2_b32 v[72:73], v231 offset0:16 offset1:17
    s_mov_b32 m0, s89
    v_mfma_f32_16x16x32_bf16 v[48:51], v[168:171], v[200:203], v[48:51]
    ds_read2_b32 v[74:75], v231 offset0:18 offset1:19
    v_mfma_f32_16x16x32_bf16 v[52:55], v[168:171], v[204:207], v[52:55]
    ds_read2_b32 v[76:77], v231 offset0:144 offset1:145
    s_add_u32 s89, s89, 2048
    v_mfma_f32_16x16x32_bf16 v[56:59], v[168:171], v[208:211], v[56:59]
    ds_read2_b32 v[78:79], v231 offset0:146 offset1:147
    buffer_load_dwordx4 v16, s[52:55], s90 offen lds
    v_mfma_f32_16x16x32_bf16 v[60:63], v[168:171], v[212:215], v[60:63]
    v_mfma_f32_16x16x32_bf16 v[44:47], v[172:175], v[192:195], v[44:47]
    ds_read2_b32 v[80:81], v232 offset0:16 offset1:17
    buffer_load_dwordx4 v19, s[52:55], s90 offen offset:1024 lds
    v_mfma_f32_16x16x32_bf16 v[48:51], v[172:175], v[196:199], v[48:51]
    ds_read2_b32 v[82:83], v232 offset0:18 offset1:19
    s_add_u32 s90, s90, 16384
    v_mfma_f32_16x16x32_bf16 v[52:55], v[172:175], v[200:203], v[52:55]
    ds_read2_b32 v[84:85], v232 offset0:144 offset1:145
    v_mfma_f32_16x16x32_bf16 v[56:59], v[172:175], v[204:207], v[56:59]
    ds_read2_b32 v[86:87], v232 offset0:146 offset1:147
    s_cmp_ge_u32 s90, 458752
    v_mfma_f32_16x16x32_bf16 v[60:63], v[172:175], v[208:211], v[60:63]
    s_cselect_b32 s91, 458752, 0
    v_mfma_f32_16x16x32_bf16 v[48:51], v[176:179], v[192:195], v[48:51]
    ds_read2_b32 v[88:89], v233 offset0:16 offset1:17
    v_mfma_f32_16x16x32_bf16 v[52:55], v[176:179], v[196:199], v[52:55]
    ds_read2_b32 v[90:91], v233 offset0:18 offset1:19
    s_sub_u32 s90, s90, s91
    v_mfma_f32_16x16x32_bf16 v[56:59], v[176:179], v[200:203], v[56:59]
    ds_read2_b32 v[92:93], v233 offset0:144 offset1:145
    s_mov_b32 m0, s89
    v_mfma_f32_16x16x32_bf16 v[60:63], v[176:179], v[204:207], v[60:63]
    ds_read2_b32 v[94:95], v233 offset0:146 offset1:147
    v_mfma_f32_16x16x32_bf16 v[52:55], v[180:183], v[192:195], v[52:55]
    s_add_u32 s89, s89, 2048
    v_mfma_f32_16x16x32_bf16 v[56:59], v[180:183], v[196:199], v[56:59]
    buffer_load_dwordx4 v16, s[52:55], s90 offen lds
    v_mfma_f32_16x16x32_bf16 v[60:63], v[180:183], v[200:203], v[60:63]
    v_mfma_f32_16x16x32_bf16 v[56:59], v[184:187], v[192:195], v[56:59]
    buffer_load_dwordx4 v19, s[52:55], s90 offen offset:1024 lds
    v_mfma_f32_16x16x32_bf16 v[60:63], v[184:187], v[196:199], v[60:63]
    s_add_u32 s90, s90, 16384
    v_mfma_f32_16x16x32_bf16 v[60:63], v[188:191], v[192:195], v[60:63]
    s_waitcnt lgkmcnt(0)
    v_mfma_f32_16x16x32_bf16 v[32:35], v[64:67], v[96:99], v[32:35]
    v_mfma_f32_16x16x32_bf16 v[36:39], v[64:67], v[100:103], v[36:39]
    ds_read2_b32 v[160:161], v230 offset0:32 offset1:33
    s_cmp_ge_u32 s90, 458752
    v_mfma_f32_16x16x32_bf16 v[40:43], v[64:67], v[104:107], v[40:43]
    ds_read2_b32 v[162:163], v230 offset0:34 offset1:35
    v_mfma_f32_16x16x32_bf16 v[44:47], v[64:67], v[108:111], v[44:47]
    ds_read_b128 v[192:195], v234 offset:32
    s_cselect_b32 s91, 458752, 0
    v_mfma_f32_16x16x32_bf16 v[48:51], v[64:67], v[112:115], v[48:51]
    ds_read_b128 v[196:199], v234 offset:288
    s_sub_u32 s90, s90, s91
    v_mfma_f32_16x16x32_bf16 v[52:55], v[64:67], v[116:119], v[52:55]
    v_mfma_f32_16x16x32_bf16 v[56:59], v[64:67], v[120:123], v[56:59]
    ds_read_b128 v[200:203], v234 offset:544
    s_mov_b32 m0, s89
    v_mfma_f32_16x16x32_bf16 v[60:63], v[64:67], v[124:127], v[60:63]
    ds_read_b128 v[204:207], v234 offset:800
    s_add_u32 s89, s89, 2048
    v_mfma_f32_16x16x32_bf16 v[36:39], v[68:71], v[96:99], v[36:39]
    ds_read_b128 v[208:211], v234 offset:1056
    v_mfma_f32_16x16x32_bf16 v[40:43], v[68:71], v[100:103], v[40:43]
    ds_read_b128 v[212:215], v234 offset:1312
    buffer_load_dwordx4 v16, s[52:55], s90 offen lds
    v_mfma_f32_16x16x32_bf16 v[44:47], v[68:71], v[104:107], v[44:47]
    v_mfma_f32_16x16x32_bf16 v[48:51], v[68:71], v[108:111], v[48:51]
    ds_read_b128 v[216:219], v234 offset:1568
    buffer_load_dwordx4 v19, s[52:55], s90 offen offset:1024 lds
    v_mfma_f32_16x16x32_bf16 v[52:55], v[68:71], v[112:115], v[52:55]
    ds_read_b128 v[220:223], v234 offset:1824
    s_add_u32 s90, s90, 16384
    v_mfma_f32_16x16x32_bf16 v[56:59], v[68:71], v[116:119], v[56:59]
    ds_read2_b32 v[164:165], v230 offset0:160 offset1:161
    v_mfma_f32_16x16x32_bf16 v[60:63], v[68:71], v[120:123], v[60:63]
    ds_read2_b32 v[166:167], v230 offset0:162 offset1:163
    s_cmp_ge_u32 s90, 458752
    v_mfma_f32_16x16x32_bf16 v[40:43], v[72:75], v[96:99], v[40:43]
    s_cselect_b32 s91, 458752, 0
    v_mfma_f32_16x16x32_bf16 v[44:47], v[72:75], v[100:103], v[44:47]
    ds_read2_b32 v[168:169], v231 offset0:32 offset1:33
    v_mfma_f32_16x16x32_bf16 v[48:51], v[72:75], v[104:107], v[48:51]
    ds_read2_b32 v[170:171], v231 offset0:34 offset1:35
    s_sub_u32 s90, s90, s91
    v_mfma_f32_16x16x32_bf16 v[52:55], v[72:75], v[108:111], v[52:55]
    ds_read2_b32 v[172:173], v231 offset0:160 offset1:161
    v_mfma_f32_16x16x32_bf16 v[56:59], v[72:75], v[112:115], v[56:59]
    ds_read2_b32 v[174:175], v231 offset0:162 offset1:163
    s_mov_b32 m0, s89
    v_mfma_f32_16x16x32_bf16 v[60:63], v[72:75], v[116:119], v[60:63]
    s_add_u32 s89, s89, 2048
    v_mfma_f32_16x16x32_bf16 v[44:47], v[76:79], v[96:99], v[44:47]
    ds_read2_b32 v[176:177], v232 offset0:32 offset1:33
    v_mfma_f32_16x16x32_bf16 v[48:51], v[76:79], v[100:103], v[48:51]
    ds_read2_b32 v[178:179], v232 offset0:34 offset1:35
    buffer_load_dwordx4 v16, s[52:55], s90 offen lds
    v_mfma_f32_16x16x32_bf16 v[52:55], v[76:79], v[104:107], v[52:55]
    ds_read2_b32 v[180:181], v232 offset0:160 offset1:161
    buffer_load_dwordx4 v19, s[52:55], s90 offen offset:1024 lds
    v_mfma_f32_16x16x32_bf16 v[56:59], v[76:79], v[108:111], v[56:59]
    ds_read2_b32 v[182:183], v232 offset0:162 offset1:163
    v_mfma_f32_16x16x32_bf16 v[60:63], v[76:79], v[112:115], v[60:63]
    s_add_u32 s90, s90, 16384
    v_mfma_f32_16x16x32_bf16 v[48:51], v[80:83], v[96:99], v[48:51]
    ds_read2_b32 v[184:185], v233 offset0:32 offset1:33
    v_mfma_f32_16x16x32_bf16 v[52:55], v[80:83], v[100:103], v[52:55]
    ds_read2_b32 v[186:187], v233 offset0:34 offset1:35
    s_cmp_ge_u32 s90, 458752
    v_mfma_f32_16x16x32_bf16 v[56:59], v[80:83], v[104:107], v[56:59]
    ds_read2_b32 v[188:189], v233 offset0:160 offset1:161
    s_cselect_b32 s91, 458752, 0
    v_mfma_f32_16x16x32_bf16 v[60:63], v[80:83], v[108:111], v[60:63]
    ds_read2_b32 v[190:191], v233 offset0:162 offset1:163
    v_mfma_f32_16x16x32_bf16 v[52:55], v[84:87], v[96:99], v[52:55]
    s_sub_u32 s90, s90, s91
    v_mfma_f32_16x16x32_bf16 v[56:59], v[84:87], v[100:103], v[56:59]
    s_mov_b32 m0, s89
    v_mfma_f32_16x16x32_bf16 v[60:63], v[84:87], v[104:107], v[60:63]
    v_mfma_f32_16x16x32_bf16 v[56:59], v[88:91], v[96:99], v[56:59]
    s_add_u32 s89, s89, 2048
    v_mfma_f32_16x16x32_bf16 v[60:63], v[88:91], v[100:103], v[60:63]
    buffer_load_dwordx4 v16, s[52:55], s90 offen lds
    v_mfma_f32_16x16x32_bf16 v[60:63], v[92:95], v[96:99], v[60:63]
    s_waitcnt lgkmcnt(0)
    v_mfma_f32_16x16x32_bf16 v[32:35], v[160:163], v[192:195], v[32:35]
    v_mfma_f32_16x16x32_bf16 v[36:39], v[160:163], v[196:199], v[36:39]
    ds_read2_b32 v[64:65], v230 offset0:48 offset1:49
    buffer_load_dwordx4 v19, s[52:55], s90 offen offset:1024 lds
    v_mfma_f32_16x16x32_bf16 v[40:43], v[160:163], v[200:203], v[40:43]
    ds_read2_b32 v[66:67], v230 offset0:50 offset1:51
    v_mfma_f32_16x16x32_bf16 v[44:47], v[160:163], v[204:207], v[44:47]
    ds_read_b128 v[96:99], v234 offset:0
    s_add_u32 s90, s90, 16384
    v_mfma_f32_16x16x32_bf16 v[48:51], v[160:163], v[208:211], v[48:51]
    ds_read_b128 v[100:103], v234 offset:256
    s_cmp_ge_u32 s90, 458752
    v_mfma_f32_16x16x32_bf16 v[52:55], v[160:163], v[212:215], v[52:55]
    v_mfma_f32_16x16x32_bf16 v[56:59], v[160:163], v[216:219], v[56:59]
    ds_read_b128 v[104:107], v234 offset:512
    s_cselect_b32 s91, 458752, 0
    v_mfma_f32_16x16x32_bf16 v[60:63], v[160:163], v[220:223], v[60:63]
    ds_read_b128 v[108:111], v234 offset:768
    s_sub_u32 s90, s90, s91
    v_mfma_f32_16x16x32_bf16 v[36:39], v[164:167], v[192:195], v[36:39]
    ds_read_b128 v[112:115], v234 offset:1024
    v_mfma_f32_16x16x32_bf16 v[40:43], v[164:167], v[196:199], v[40:43]
    ds_read_b128 v[116:119], v234 offset:1280
    s_mov_b32 m0, s89
    v_mfma_f32_16x16x32_bf16 v[44:47], v[164:167], v[200:203], v[44:47]
    s_add_u32 s89, s89, 2048
    v_mfma_f32_16x16x32_bf16 v[48:51], v[164:167], v[204:207], v[48:51]
    ds_read_b128 v[120:123], v234 offset:1536
    v_mfma_f32_16x16x32_bf16 v[52:55], v[164:167], v[208:211], v[52:55]
    ds_read_b128 v[124:127], v234 offset:1792
    buffer_load_dwordx4 v16, s[52:55], s90 offen lds
    v_mfma_f32_16x16x32_bf16 v[56:59], v[164:167], v[212:215], v[56:59]
    ds_read2_b32 v[68:69], v230 offset0:176 offset1:177
    buffer_load_dwordx4 v19, s[52:55], s90 offen offset:1024 lds
    v_mfma_f32_16x16x32_bf16 v[60:63], v[164:167], v[216:219], v[60:63]
    ds_read2_b32 v[70:71], v230 offset0:178 offset1:179
    v_mfma_f32_16x16x32_bf16 v[40:43], v[168:171], v[192:195], v[40:43]
    s_add_u32 s90, s90, 16384
    v_mfma_f32_16x16x32_bf16 v[44:47], v[168:171], v[196:199], v[44:47]
    ds_read2_b32 v[72:73], v231 offset0:48 offset1:49
    s_cmp_ge_u32 s90, 458752
    v_mfma_f32_16x16x32_bf16 v[48:51], v[168:171], v[200:203], v[48:51]
    ds_read2_b32 v[74:75], v231 offset0:50 offset1:51
    v_mfma_f32_16x16x32_bf16 v[52:55], v[168:171], v[204:207], v[52:55]
    ds_read2_b32 v[76:77], v231 offset0:176 offset1:177
    s_cselect_b32 s91, 458752, 0
    v_mfma_f32_16x16x32_bf16 v[56:59], v[168:171], v[208:211], v[56:59]
    ds_read2_b32 v[78:79], v231 offset0:178 offset1:179
    s_sub_u32 s90, s90, s91
    v_mfma_f32_16x16x32_bf16 v[60:63], v[168:171], v[212:215], v[60:63]
    v_mfma_f32_16x16x32_bf16 v[44:47], v[172:175], v[192:195], v[44:47]
    ds_read2_b32 v[80:81], v232 offset0:48 offset1:49
    s_mov_b32 m0, s89
    v_mfma_f32_16x16x32_bf16 v[48:51], v[172:175], v[196:199], v[48:51]
    ds_read2_b32 v[82:83], v232 offset0:50 offset1:51
    s_add_u32 s89, s89, 2048
    v_mfma_f32_16x16x32_bf16 v[52:55], v[172:175], v[200:203], v[52:55]
    ds_read2_b32 v[84:85], v232 offset0:176 offset1:177
    v_mfma_f32_16x16x32_bf16 v[56:59], v[172:175], v[204:207], v[56:59]
    ds_read2_b32 v[86:87], v232 offset0:178 offset1:179
    buffer_load_dwordx4 v16, s[52:55], s90 offen lds
    v_mfma_f32_16x16x32_bf16 v[60:63], v[172:175], v[208:211], v[60:63]
    buffer_load_dwordx4 v19, s[52:55], s90 offen offset:1024 lds
    v_mfma_f32_16x16x32_bf16 v[48:51], v[176:179], v[192:195], v[48:51]
    ds_read2_b32 v[88:89], v233 offset0:48 offset1:49
    v_mfma_f32_16x16x32_bf16 v[52:55], v[176:179], v[196:199], v[52:55]
    ds_read2_b32 v[90:91], v233 offset0:50 offset1:51
    s_add_u32 s90, s90, 16384
    v_mfma_f32_16x16x32_bf16 v[56:59], v[176:179], v[200:203], v[56:59]
    ds_read2_b32 v[92:93], v233 offset0:176 offset1:177
    s_cmp_ge_u32 s90, 458752
    v_mfma_f32_16x16x32_bf16 v[60:63], v[176:179], v[204:207], v[60:63]
    ds_read2_b32 v[94:95], v233 offset0:178 offset1:179
    v_mfma_f32_16x16x32_bf16 v[52:55], v[180:183], v[192:195], v[52:55]
    s_cselect_b32 s91, 458752, 0
    v_mfma_f32_16x16x32_bf16 v[56:59], v[180:183], v[196:199], v[56:59]
    s_sub_u32 s90, s90, s91
    v_mfma_f32_16x16x32_bf16 v[60:63], v[180:183], v[200:203], v[60:63]
    v_mfma_f32_16x16x32_bf16 v[56:59], v[184:187], v[192:195], v[56:59]
    s_mov_b32 m0, s89
    v_mfma_f32_16x16x32_bf16 v[60:63], v[184:187], v[196:199], v[60:63]
    s_add_u32 s89, s89, 2048
    v_mfma_f32_16x16x32_bf16 v[60:63], v[188:191], v[192:195], v[60:63]
    s_waitcnt lgkmcnt(0)
    v_mfma_f32_16x16x32_bf16 v[32:35], v[64:67], v[96:99], v[32:35]
    v_mfma_f32_16x16x32_bf16 v[36:39], v[64:67], v[100:103], v[36:39]
    buffer_load_dwordx4 v16, s[52:55], s90 offen lds
    v_mfma_f32_16x16x32_bf16 v[40:43], v[64:67], v[104:107], v[40:43]
    v_mfma_f32_16x16x32_bf16 v[44:47], v[64:67], v[108:111], v[44:47]
    buffer_load_dwordx4 v19, s[52:55], s90 offen offset:1024 lds
    v_mfma_f32_16x16x32_bf16 v[48:51], v[64:67], v[112:115], v[48:51]
    s_add_u32 s90, s90, 16384
    v_mfma_f32_16x16x32_bf16 v[52:55], v[64:67], v[116:119], v[52:55]
    v_mfma_f32_16x16x32_bf16 v[56:59], v[64:67], v[120:123], v[56:59]
    s_cmp_ge_u32 s90, 458752
    v_mfma_f32_16x16x32_bf16 v[60:63], v[64:67], v[124:127], v[60:63]
    s_cselect_b32 s91, 458752, 0
    v_mfma_f32_16x16x32_bf16 v[36:39], v[68:71], v[96:99], v[36:39]
    v_mfma_f32_16x16x32_bf16 v[40:43], v[68:71], v[100:103], v[40:43]
    s_sub_u32 s90, s90, s91
    v_mfma_f32_16x16x32_bf16 v[44:47], v[68:71], v[104:107], v[44:47]
    v_mfma_f32_16x16x32_bf16 v[48:51], v[68:71], v[108:111], v[48:51]
    s_mov_b32 m0, s89
    v_mfma_f32_16x16x32_bf16 v[52:55], v[68:71], v[112:115], v[52:55]
    s_add_u32 s89, s89, 2048
    v_mfma_f32_16x16x32_bf16 v[56:59], v[68:71], v[116:119], v[56:59]
    v_mfma_f32_16x16x32_bf16 v[60:63], v[68:71], v[120:123], v[60:63]
    buffer_load_dwordx4 v16, s[52:55], s90 offen lds
    v_mfma_f32_16x16x32_bf16 v[40:43], v[72:75], v[96:99], v[40:43]
    buffer_load_dwordx4 v19, s[52:55], s90 offen offset:1024 lds
    v_mfma_f32_16x16x32_bf16 v[44:47], v[72:75], v[100:103], v[44:47]
    v_mfma_f32_16x16x32_bf16 v[48:51], v[72:75], v[104:107], v[48:51]
    s_add_u32 s90, s90, 16384
    v_mfma_f32_16x16x32_bf16 v[52:55], v[72:75], v[108:111], v[52:55]
    v_mfma_f32_16x16x32_bf16 v[56:59], v[72:75], v[112:115], v[56:59]
    s_cmp_ge_u32 s90, 458752
    v_mfma_f32_16x16x32_bf16 v[60:63], v[72:75], v[116:119], v[60:63]
    s_cselect_b32 s91, 458752, 0
    v_mfma_f32_16x16x32_bf16 v[44:47], v[76:79], v[96:99], v[44:47]
    v_mfma_f32_16x16x32_bf16 v[48:51], v[76:79], v[100:103], v[48:51]
    s_sub_u32 s90, s90, s91
    v_mfma_f32_16x16x32_bf16 v[52:55], v[76:79], v[104:107], v[52:55]
    s_mov_b32 m0, s89
    v_mfma_f32_16x16x32_bf16 v[56:59], v[76:79], v[108:111], v[56:59]
    v_mfma_f32_16x16x32_bf16 v[60:63], v[76:79], v[112:115], v[60:63]
    s_add_u32 s89, s89, 2048
    v_mfma_f32_16x16x32_bf16 v[48:51], v[80:83], v[96:99], v[48:51]
    v_mfma_f32_16x16x32_bf16 v[52:55], v[80:83], v[100:103], v[52:55]
    buffer_load_dwordx4 v16, s[52:55], s90 offen lds
    v_mfma_f32_16x16x32_bf16 v[56:59], v[80:83], v[104:107], v[56:59]
    buffer_load_dwordx4 v19, s[52:55], s90 offen offset:1024 lds
    v_mfma_f32_16x16x32_bf16 v[60:63], v[80:83], v[108:111], v[60:63]
    v_mfma_f32_16x16x32_bf16 v[52:55], v[84:87], v[96:99], v[52:55]
    s_add_u32 s90, s90, 16384
    v_mfma_f32_16x16x32_bf16 v[56:59], v[84:87], v[100:103], v[56:59]
    s_cmp_ge_u32 s90, 458752
    v_mfma_f32_16x16x32_bf16 v[60:63], v[84:87], v[104:107], v[60:63]
    v_mfma_f32_16x16x32_bf16 v[56:59], v[88:91], v[96:99], v[56:59]
    s_cselect_b32 s91, 458752, 0
    v_mfma_f32_16x16x32_bf16 v[60:63], v[88:91], v[100:103], v[60:63]
    s_sub_u32 s90, s90, s91
    v_mfma_f32_16x16x32_bf16 v[60:63], v[92:95], v[96:99], v[60:63]
    s_mul_i32 s67, s39, 10240
    s_add_u32 s67, s67, 26624
    v_mul_u32_u24 v5, 80, v228
    v_lshlrev_b32 v6, 4, v229
    v_add3_u32 v5, v5, v6, s67
    ds_write_b128 v5, v[32:35] offset:0
    ds_write_b128 v5, v[36:39] offset:1280
    ds_write_b128 v5, v[40:43] offset:2560
    ds_write_b128 v5, v[44:47] offset:3840
    ds_write_b128 v5, v[48:51] offset:5120
    ds_write_b128 v5, v[52:55] offset:6400
    ds_write_b128 v5, v[56:59] offset:7680
    ds_write_b128 v5, v[60:63] offset:8960
    v_lshrrev_b32 v5, 3, v0
    v_mul_u32_u24 v5, 80, v5
    v_and_b32 v6, 7, v0
    v_lshlrev_b32 v6, 3, v6
    v_add_u32 v5, v5, v6
    v_lshlrev_b32 v7, 3, v1
    s_lshl_b32 s67, s42, 9
    s_lshl_b32 s68, s39, 17
    s_add_u32 s67, s67, s68
    s_add_u32 s67, s67, 1048576
    s_waitcnt lgkmcnt(0)
    s_barrier
    ds_read_b64 v[64:65], v5 offset:26624
    ds_read_b64 v[66:67], v5 offset:36864
    ds_read_b64 v[68:69], v5 offset:47104
    ds_read_b64 v[70:71], v5 offset:57344
    ds_read_b64 v[72:73], v5 offset:29184
    ds_read_b64 v[74:75], v5 offset:39424
    ds_read_b64 v[76:77], v5 offset:49664
    ds_read_b64 v[78:79], v5 offset:59904
    ds_read_b64 v[80:81], v5 offset:31744
    ds_read_b64 v[82:83], v5 offset:41984
    ds_read_b64 v[84:85], v5 offset:52224
    ds_read_b64 v[86:87], v5 offset:62464
    ds_read_b64 v[88:89], v5 offset:34304
    ds_read_b64 v[90:91], v5 offset:44544
    ds_read_b64 v[92:93], v5 offset:54784
    ds_read_b64 v[94:95], v5 offset:65024
    s_waitcnt lgkmcnt(8)
    v_add_f32 v96, v64, v66
    v_add_f32 v97, v68, v70
    v_add_f32 v98, v65, v67
    v_add_f32 v99, v69, v71
    v_add_f32 v100, v72, v74
    v_add_f32 v101, v76, v78
    v_add_f32 v102, v73, v75
    v_add_f32 v103, v77, v79
    v_cvt_pk_bf16_f32 v112, v96, v97
    v_cvt_pk_bf16_f32 v113, v98, v99
    v_cvt_pk_bf16_f32 v114, v100, v101
    v_cvt_pk_bf16_f32 v115, v102, v103
    v_lshlrev_b32 v96, 16, v112
    v_and_b32 v97, 0xffff0000, v112
    v_lshlrev_b32 v98, 16, v113
    v_and_b32 v99, 0xffff0000, v113
    v_lshlrev_b32 v100, 16, v114
    v_and_b32 v101, 0xffff0000, v114
    v_lshlrev_b32 v102, 16, v115
    v_and_b32 v103, 0xffff0000, v115
    v_pk_add_f32 v[96:97], v[96:97], v[144:145]
    v_pk_add_f32 v[98:99], v[98:99], v[146:147]
    v_pk_add_f32 v[100:101], v[100:101], v[148:149]
    v_pk_add_f32 v[102:103], v[102:103], v[150:151]
    v_cvt_pk_bf16_f32 v112, v96, v97
    v_cvt_pk_bf16_f32 v113, v98, v99
    v_cvt_pk_bf16_f32 v114, v100, v101
    v_cvt_pk_bf16_f32 v115, v102, v103
    v_lshlrev_b32 v96, 16, v112
    v_and_b32 v97, 0xffff0000, v112
    v_lshlrev_b32 v98, 16, v113
    v_and_b32 v99, 0xffff0000, v113
    v_lshlrev_b32 v100, 16, v114
    v_and_b32 v101, 0xffff0000, v114
    v_lshlrev_b32 v102, 16, v115
    v_and_b32 v103, 0xffff0000, v115
    v_pk_add_f32 v[96:97], v[96:97], v[128:129]
    v_pk_add_f32 v[98:99], v[98:99], v[130:131]
    v_pk_add_f32 v[100:101], v[100:101], v[132:133]
    v_pk_add_f32 v[102:103], v[102:103], v[134:135]
    v_cvt_pk_bf16_f32 v112, v96, v97
    v_cvt_pk_bf16_f32 v113, v98, v99
    v_cvt_pk_bf16_f32 v114, v100, v101
    v_cvt_pk_bf16_f32 v115, v102, v103
    buffer_store_dwordx2 v[112:113], v7, s[44:47], s67 offen sc1
    s_add_u32 s67, s67, 524288
    buffer_store_dwordx2 v[114:115], v7, s[44:47], s67 offen sc1
    s_add_u32 s67, s67, 524288
    s_waitcnt lgkmcnt(0)
    v_add_f32 v104, v80, v82
    v_add_f32 v105, v84, v86
    v_add_f32 v106, v81, v83
    v_add_f32 v107, v85, v87
    v_add_f32 v108, v88, v90
    v_add_f32 v109, v92, v94
    v_add_f32 v110, v89, v91
    v_add_f32 v111, v93, v95
    v_cvt_pk_bf16_f32 v116, v104, v105
    v_cvt_pk_bf16_f32 v117, v106, v107
    v_cvt_pk_bf16_f32 v118, v108, v109
    v_cvt_pk_bf16_f32 v119, v110, v111
    v_lshlrev_b32 v104, 16, v116
    v_and_b32 v105, 0xffff0000, v116
    v_lshlrev_b32 v106, 16, v117
    v_and_b32 v107, 0xffff0000, v117
    v_lshlrev_b32 v108, 16, v118
    v_and_b32 v109, 0xffff0000, v118
    v_lshlrev_b32 v110, 16, v119
    v_and_b32 v111, 0xffff0000, v119
    v_pk_add_f32 v[104:105], v[104:105], v[152:153]
    v_pk_add_f32 v[106:107], v[106:107], v[154:155]
    v_pk_add_f32 v[108:109], v[108:109], v[156:157]
    v_pk_add_f32 v[110:111], v[110:111], v[158:159]
    v_cvt_pk_bf16_f32 v116, v104, v105
    v_cvt_pk_bf16_f32 v117, v106, v107
    v_cvt_pk_bf16_f32 v118, v108, v109
    v_cvt_pk_bf16_f32 v119, v110, v111
    v_lshlrev_b32 v104, 16, v116
    v_and_b32 v105, 0xffff0000, v116
    v_lshlrev_b32 v106, 16, v117
    v_and_b32 v107, 0xffff0000, v117
    v_lshlrev_b32 v108, 16, v118
    v_and_b32 v109, 0xffff0000, v118
    v_lshlrev_b32 v110, 16, v119
    v_and_b32 v111, 0xffff0000, v119
    v_pk_add_f32 v[104:105], v[104:105], v[136:137]
    v_pk_add_f32 v[106:107], v[106:107], v[138:139]
    v_pk_add_f32 v[108:109], v[108:109], v[140:141]
    v_pk_add_f32 v[110:111], v[110:111], v[142:143]
    v_cvt_pk_bf16_f32 v116, v104, v105
    v_cvt_pk_bf16_f32 v117, v106, v107
    v_cvt_pk_bf16_f32 v118, v108, v109
    v_cvt_pk_bf16_f32 v119, v110, v111
    buffer_store_dwordx2 v[116:117], v7, s[44:47], s67 offen sc1
    s_add_u32 s67, s67, 524288
    buffer_store_dwordx2 v[118:119], v7, s[44:47], s67 offen sc1
    s_cmp_ge_u32 s41, 28
    s_cbranch_scc1 L_now1e_4
    s_cmp_ge_u32 s41, 14
    s_cselect_b32 s77, 14, 0
    s_sub_u32 s77, s41, s77
    s_lshl_b32 s77, s77, 8
    v_lshrrev_b32 v28, 4, v1
    v_and_b32 v29, 15, v1
    v_lshlrev_b32 v30, 2, v28
    v_xor_b32 v29, v29, v30
    v_lshlrev_b32 v29, 4, v29
    v_mul_u32_u24 v28, 3584, v28
    v_add3_u32 v29, v28, v29, s77
    s_lshl_b32 s78, s39, 10
    s_mul_i32 s79, s39, 14336
    s_mov_b32 m0, s78
    s_add_u32 s78, s78, 4096
    buffer_load_dwordx4 v29, s[56:59], s79 offen lds
    s_add_u32 s79, s79, 57344
    s_mov_b32 m0, s78
    s_add_u32 s78, s78, 4096
    buffer_load_dwordx4 v29, s[56:59], s79 offen lds
    s_add_u32 s79, s79, 57344
    s_mov_b32 m0, s78
    s_add_u32 s78, s78, 4096
    buffer_load_dwordx4 v29, s[56:59], s79 offen lds
    s_add_u32 s79, s79, 57344
    s_mov_b32 m0, s78
    s_add_u32 s78, s78, 4096
    buffer_load_dwordx4 v29, s[56:59], s79 offen lds
    s_add_u32 s79, s79, 57344
    s_mov_b32 m0, s78
    s_add_u32 s78, s78, 4096
    buffer_load_dwordx4 v29, s[56:59], s79 offen lds
    s_add_u32 s79, s79, 57344
    s_mov_b32 m0, s78
    s_add_u32 s78, s78, 4096
    buffer_load_dwordx4 v29, s[56:59], s79 offen lds
    s_add_u32 s79, s79, 57344
    s_waitcnt vmcnt(6)
    s_branch L_w1ej_5
L_now1e_4:
    s_waitcnt vmcnt(0)
L_w1ej_5:
    s_barrier
    s_cmp_lg_u32 s39, 0
    s_cbranch_scc1 L_fl_6
    s_lshl_b32 s67, s2, 7
    s_add_u32 s67, s67, 131072
    v_mov_b32 v5, 0
    v_mov_b32 v6, s38
    s_mov_b64 s[72:73], exec
    s_mov_b64 exec, 1
    buffer_store_dword v6, v5, s[44:47], s67 offen sc1
    s_mov_b64 exec, s[72:73]
L_fl_6:
    s_cmp_ge_u32 s41, 28
    s_cbranch_scc1 L_skipD
    s_cmp_ge_u32 s41, 14
    s_cselect_b32 s60, 1, 0
    s_cselect_b32 s61, 14, 0
    s_sub_u32 s61, s41, s61
    s_lshl_b32 s62, s40, 1
    s_add_u32 s60, s60, s62
    s_mul_i32 s75, s61, 0
    s_lshr_b32 s75, s75, 2
    s_mov_b32 m0, s78
    s_add_u32 s78, s78, 4096
    buffer_load_dwordx4 v29, s[56:59], s79 offen lds
    s_add_u32 s79, s79, 57344
    s_mov_b32 m0, s78
    s_add_u32 s78, s78, 4096
    buffer_load_dwordx4 v29, s[56:59], s79 offen lds
    s_add_u32 s79, s79, 57344
    s_mov_b32 m0, s78
    s_add_u32 s78, s78, 4096
    buffer_load_dwordx4 v29, s[56:59], s79 offen lds
    s_add_u32 s79, s79, 57344
    s_mov_b32 m0, s78
    s_add_u32 s78, s78, 4096
    buffer_load_dwordx4 v29, s[56:59], s79 offen lds
    s_add_u32 s79, s79, 57344
    s_mov_b32 m0, s78
    s_add_u32 s78, s78, 4096
    buffer_load_dwordx4 v29, s[56:59], s79 offen lds
    s_add_u32 s79, s79, 57344
    s_mov_b32 m0, s78
    s_add_u32 s78, s78, 4096
    buffer_load_dwordx4 v29, s[56:59], s79 offen lds
    s_add_u32 s79, s79, 57344
    s_mov_b32 m0, s78
    s_add_u32 s78, s78, 4096
    buffer_load_dwordx4 v29, s[56:59], s79 offen lds
    s_add_u32 s79, s79, 57344
    s_mov_b32 m0, s78
    s_add_u32 s78, s78, 4096
    buffer_load_dwordx4 v29, s[56:59], s79 offen lds
    s_add_u32 s79, s79, 57344
    s_mov_b32 m0, s78
    s_add_u32 s78, s78, 4096
    buffer_load_dwordx4 v29, s[56:59], s79 offen lds
    s_add_u32 s79, s79, 57344
    s_mov_b32 m0, s78
    s_add_u32 s78, s78, 4096
    buffer_load_dwordx4 v29, s[56:59], s79 offen lds
    s_add_u32 s79, s79, 57344
    s_mov_b32 m0, s78
    s_add_u32 s78, s78, 4096
    buffer_load_dwordx4 v29, s[56:59], s79 offen lds
    s_add_u32 s79, s79, 57344
    s_mul_i32 s91, s39, 22528
    s_add_u32 s91, s91, 69632
    v_add_u32 v30, s91, v17
    v_add_u32 v31, s91, v18
    ds_read_b64_tr_b16 a[16:17], v30 offset:0
    ds_read_b64_tr_b16 a[18:19], v30 offset:1024
    ds_read_b64_tr_b16 a[128:129], v31 offset:0
    ds_read_b64_tr_b16 a[130:131], v31 offset:1024
    ds_read_b64_tr_b16 a[20:21], v30 offset:2048
    ds_read_b64_tr_b16 a[22:23], v30 offset:3072
    ds_read_b64_tr_b16 a[132:133], v31 offset:2048
    ds_read_b64_tr_b16 a[134:135], v31 offset:3072
    ds_read_b64_tr_b16 a[24:25], v30 offset:4096
    ds_read_b64_tr_b16 a[26:27], v30 offset:5120
    ds_read_b64_tr_b16 a[136:137], v31 offset:4096
    ds_read_b64_tr_b16 a[138:139], v31 offset:5120
    ds_read_b64_tr_b16 a[28:29], v30 offset:6144
    ds_read_b64_tr_b16 a[30:31], v30 offset:7168
    ds_read_b64_tr_b16 a[140:141], v31 offset:6144
    ds_read_b64_tr_b16 a[142:143], v31 offset:7168
    ds_read_b64_tr_b16 a[32:33], v30 offset:8192
    ds_read_b64_tr_b16 a[34:35], v30 offset:9216
    ds_read_b64_tr_b16 a[144:145], v31 offset:8192
    ds_read_b64_tr_b16 a[146:147], v31 offset:9216
    ds_read_b64_tr_b16 a[36:37], v30 offset:10240
    ds_read_b64_tr_b16 a[38:39], v30 offset:11264
    ds_read_b64_tr_b16 a[148:149], v31 offset:10240
    ds_read_b64_tr_b16 a[150:151], v31 offset:11264
    ds_read_b64_tr_b16 a[40:41], v30 offset:12288
    ds_read_b64_tr_b16 a[42:43], v30 offset:13312
    ds_read_b64_tr_b16 a[152:153], v31 offset:12288
    ds_read_b64_tr_b16 a[154:155], v31 offset:13312
    ds_read_b64_tr_b16 a[44:45], v30 offset:14336
    ds_read_b64_tr_b16 a[46:47], v30 offset:15360
    ds_read_b64_tr_b16 a[156:157], v31 offset:14336
    ds_read_b64_tr_b16 a[158:159], v31 offset:15360
    ds_read_b64_tr_b16 a[48:49], v30 offset:16384
    ds_read_b64_tr_b16 a[50:51], v30 offset:17408
    ds_read_b64_tr_b16 a[160:161], v31 offset:16384
    ds_read_b64_tr_b16 a[162:163], v31 offset:17408
    ds_read_b64_tr_b16 a[52:53], v30 offset:18432
    ds_read_b64_tr_b16 a[54:55], v30 offset:19456
    ds_read_b64_tr_b16 a[164:165], v31 offset:18432
    ds_read_b64_tr_b16 a[166:167], v31 offset:19456
    ds_read_b64_tr_b16 a[56:57], v30 offset:20480
    ds_read_b64_tr_b16 a[58:59], v30 offset:21504
    ds_read_b64_tr_b16 a[168:169], v31 offset:20480
    ds_read_b64_tr_b16 a[170:171], v31 offset:21504
    s_waitcnt lgkmcnt(0)
    s_barrier
    s_mov_b32 m0, s78
    s_add_u32 s78, s78, 4096
    buffer_load_dwordx4 v29, s[56:59], s79 offen lds
    s_add_u32 s79, s79, 57344
    s_mov_b32 m0, s78
    s_add_u32 s78, s78, 4096
    buffer_load_dwordx4 v29, s[56:59], s79 offen lds
    s_add_u32 s79, s79, 57344
    s_mov_b32 m0, s78
    s_add_u32 s78, s78, 4096
    buffer_load_dwordx4 v29, s[56:59], s79 offen lds
    s_add_u32 s79, s79, 57344
    s_mov_b32 m0, s78
    s_add_u32 s78, s78, 4096
    buffer_load_dwordx4 v29, s[56:59], s79 offen lds
    s_add_u32 s79, s79, 57344
    s_mov_b32 m0, s78
    s_add_u32 s78, s78, 4096
    buffer_load_dwordx4 v29, s[56:59], s79 offen lds
    s_add_u32 s79, s79, 57344
    s_mov_b32 m0, s78
    s_add_u32 s78, s78, 4096
    buffer_load_dwordx4 v29, s[56:59], s79 offen lds
    s_add_u32 s79, s79, 57344
    s_mov_b32 m0, s78
    s_add_u32 s78, s78, 4096
    buffer_load_dwordx4 v29, s[56:59], s79 offen lds
    s_add_u32 s79, s79, 57344
    s_mov_b32 m0, s78
    s_add_u32 s78, s78, 4096
    buffer_load_dwordx4 v29, s[56:59], s79 offen lds
    s_add_u32 s79, s79, 57344
    s_mov_b32 m0, s78
    s_add_u32 s78, s78, 4096
    buffer_load_dwordx4 v29, s[56:59], s79 offen lds
    s_add_u32 s79, s79, 57344
    s_mov_b32 m0, s78
    s_add_u32 s78, s78, 4096
    buffer_load_dwordx4 v29, s[56:59], s79 offen lds
    s_add_u32 s79, s79, 57344
    s_mov_b32 m0, s78
    s_add_u32 s78, s78, 4096
    buffer_load_dwordx4 v29, s[56:59], s79 offen lds
    s_add_u32 s79, s79, 57344
    s_mov_b32 m0, s78
    s_add_u32 s78, s78, 4096
    buffer_load_dwordx4 v29, s[56:59], s79 offen lds
    s_add_u32 s79, s79, 57344
    s_mov_b32 m0, s78
    s_add_u32 s78, s78, 4096
    buffer_load_dwordx4 v29, s[56:59], s79 offen lds
    s_add_u32 s79, s79, 57344
    s_mov_b32 m0, s78
    s_add_u32 s78, s78, 4096
    buffer_load_dwordx4 v29, s[56:59], s79 offen lds
    s_add_u32 s79, s79, 57344
    s_mov_b32 m0, s78
    s_add_u32 s78, s78, 4096
    buffer_load_dwordx4 v29, s[56:59], s79 offen lds
    s_add_u32 s79, s79, 57344
    s_lshl_b32 s64, s61, 8
    v_lshlrev_b32 v8, 1, v0
    v_add_u32 v8, s64, v8
    v_cmp_gt_u32 vcc, 128, v0
    s_nop 0
    s_and_saveexec_b64 s[72:73], vcc
    global_load_ushort v9, v8, s[26:27]
    s_mov_b64 exec, s[72:73]
    s_lshl_b32 s67, s61, 10
    s_add_u32 s67, s67, 262144
    v_and_b32 v182, 127, v0
    v_lshlrev_b32 v182, 3, v182
    s_mov_b32 s68, s67
    v_lshrrev_b32 v2, 5, v1
    v_lshlrev_b32 v3, 11, v2
    v_and_b32 v4, 31, v1
    v_lshlrev_b32 v5, 2, v4
    s_lshl_b32 s74, s60, 17
    s_lshl_b32 s64, s39, 7
    s_add_u32 s74, s74, s64
    s_add_u32 s74, s74, 1048576
    v_add3_u32 v3, v3, v5, s74
    s_lshl_b32 s63, s75, 12
    v_lshrrev_b32 v6, 4, v1
    v_and_b32 v6, 1, v6
    v_and_b32 v7, 15, v1
    v_lshrrev_b32 v8, 2, v7
    v_and_b32 v7, 3, v7
    v_lshlrev_b32 v10, 3, v2
    v_add_u32 v10, v10, v8
    v_lshlrev_b32 v10, 8, v10
    v_lshlrev_b32 v6, 1, v6
    v_lshrrev_b32 v11, 1, v7
    v_add_u32 v6, v6, v11
    v_lshlrev_b32 v6, 4, v6
    v_and_b32 v7, 1, v7
    v_lshlrev_b32 v7, 3, v7
    v_add3_u32 v10, v10, v6, v7
    v_lshlrev_b32 v8, 6, v8
    s_add_u32 s64, s39, 0
    s_and_b32 s64, s64, 3
    s_lshl_b32 s64, s64, 6
    v_xor_b32 v11, s64, v8
    v_add_u32 v12, v10, v11
    s_add_u32 s64, s39, 1
    s_and_b32 s64, s64, 3
    s_lshl_b32 s64, s64, 6
    v_xor_b32 v11, s64, v8
    v_add_u32 v13, v10, v11
    s_add_u32 s64, s39, 2
    s_and_b32 s64, s64, 3
    s_lshl_b32 s64, s64, 6
    v_xor_b32 v11, s64, v8
    v_add_u32 v14, v10, v11
    s_add_u32 s64, s39, 3
    s_and_b32 s64, s64, 3
    s_lshl_b32 s64, s64, 6
    v_xor_b32 v11, s64, v8
    v_add_u32 v15, v10, v11
    s_lshl_b32 s66, s60, 7
    s_lshl_b32 s67, s39, 5
    s_add_u32 s66, s66, s67
    s_lshl_b32 s66, s66, 4
    s_add_u32 s66, s66, 327680
    v_lshlrev_b32 v10, 4, v4
    v_mov_b32 v192, 0
    v_mov_b32 v193, 0
    v_mov_b32 v194, 0
    v_mov_b32 v195, 0
    v_mov_b32 v196, 0
    v_mov_b32 v197, 0
    v_mov_b32 v198, 0
    v_mov_b32 v199, 0
    v_mov_b32 v200, 0
    v_mov_b32 v201, 0
    v_mov_b32 v202, 0
    v_mov_b32 v203, 0
    v_mov_b32 v204, 0
    v_mov_b32 v205, 0
    v_mov_b32 v206, 0
    v_mov_b32 v207, 0
    v_lshlrev_b32 v5, 7, v0
    v_add_u32 v5, 131072, v5
    s_mov_b32 s83, 0
L_pollcf_7:
    buffer_load_dword v6, v5, s[44:47], 0 offen sc1
    s_waitcnt vmcnt(0)
    v_cmp_ne_u32 vcc, s38, v6
    s_add_u32 s83, s83, 1
    s_cmp_ge_u32 s83, 65536
    s_cbranch_scc1 L_pollcf_done_8
    s_cbranch_vccnz L_pollcf_7
L_pollcf_done_8:
    s_barrier
    buffer_load_dword v128, v3, s[44:47], s63 offen offset:0 sc1
    buffer_load_dword v129, v3, s[44:47], s63 offen offset:512 sc1
    buffer_load_dword v130, v3, s[44:47], s63 offen offset:1024 sc1
    buffer_load_dword v131, v3, s[44:47], s63 offen offset:1536 sc1
    s_add_u32 s63, s63, 4096
    buffer_load_dword v132, v3, s[44:47], s63 offen offset:0 sc1
    buffer_load_dword v133, v3, s[44:47], s63 offen offset:512 sc1
    buffer_load_dword v134, v3, s[44:47], s63 offen offset:1024 sc1
    buffer_load_dword v135, v3, s[44:47], s63 offen offset:1536 sc1
    s_add_u32 s63, s63, 4096
    buffer_load_dword v136, v3, s[44:47], s63 offen offset:0 sc1
    buffer_load_dword v137, v3, s[44:47], s63 offen offset:512 sc1
    buffer_load_dword v138, v3, s[44:47], s63 offen offset:1024 sc1
    buffer_load_dword v139, v3, s[44:47], s63 offen offset:1536 sc1
    s_add_u32 s63, s63, 4096
    buffer_load_dword v140, v3, s[44:47], s63 offen offset:0 sc1
    buffer_load_dword v141, v3, s[44:47], s63 offen offset:512 sc1
    buffer_load_dword v142, v3, s[44:47], s63 offen offset:1024 sc1
    buffer_load_dword v143, v3, s[44:47], s63 offen offset:1536 sc1
    s_add_u32 s63, s63, 4096
    buffer_load_dword v144, v3, s[44:47], s63 offen offset:0 sc1
    buffer_load_dword v145, v3, s[44:47], s63 offen offset:512 sc1
    buffer_load_dword v146, v3, s[44:47], s63 offen offset:1024 sc1
    buffer_load_dword v147, v3, s[44:47], s63 offen offset:1536 sc1
    s_add_u32 s63, s63, 4096
    buffer_load_dword v148, v3, s[44:47], s63 offen offset:0 sc1
    buffer_load_dword v149, v3, s[44:47], s63 offen offset:512 sc1
    buffer_load_dword v150, v3, s[44:47], s63 offen offset:1024 sc1
    buffer_load_dword v151, v3, s[44:47], s63 offen offset:1536 sc1
    s_add_u32 s63, s63, 4096
    buffer_load_dword v152, v3, s[44:47], s63 offen offset:0 sc1
    buffer_load_dword v153, v3, s[44:47], s63 offen offset:512 sc1
    buffer_load_dword v154, v3, s[44:47], s63 offen offset:1024 sc1
    buffer_load_dword v155, v3, s[44:47], s63 offen offset:1536 sc1
    s_add_u32 s63, s63, 4096
    v_add_u32 v20, 0x10000, v12
    v_add_u32 v21, 0x10000, v13
    v_add_u32 v22, 0x10000, v14
    v_add_u32 v23, 0x10000, v15
    ds_read_b64_tr_b16 v[32:33], v12 offset:0
    ds_read_b64_tr_b16 v[34:35], v12 offset:1024
    ds_read_b64_tr_b16 v[36:37], v13 offset:0
    ds_read_b64_tr_b16 v[38:39], v13 offset:1024
    ds_read_b64_tr_b16 v[40:41], v14 offset:0
    ds_read_b64_tr_b16 v[42:43], v14 offset:1024
    ds_read_b64_tr_b16 v[44:45], v15 offset:0
    ds_read_b64_tr_b16 v[46:47], v15 offset:1024
    ds_read_b64_tr_b16 v[48:49], v12 offset:4096
    ds_read_b64_tr_b16 v[50:51], v12 offset:5120
    ds_read_b64_tr_b16 v[52:53], v13 offset:4096
    ds_read_b64_tr_b16 v[54:55], v13 offset:5120
    ds_read_b64_tr_b16 v[56:57], v14 offset:4096
    ds_read_b64_tr_b16 v[58:59], v14 offset:5120
    ds_read_b64_tr_b16 v[60:61], v15 offset:4096
    ds_read_b64_tr_b16 v[62:63], v15 offset:5120
    s_waitcnt vmcnt(24) lgkmcnt(8)
    v_mfma_f32_32x32x16_bf16 v[64:79], v[32:35], v[128:131], 0
    ds_read_b64_tr_b16 v[160:161], v12 offset:8192
    ds_read_b64_tr_b16 v[162:163], v12 offset:9216
    buffer_load_dword v156, v3, s[44:47], s63 offen offset:0 sc1
    v_mfma_f32_32x32x16_bf16 v[80:95], v[36:39], v[128:131], 0
    ds_read_b64_tr_b16 v[164:165], v13 offset:8192
    ds_read_b64_tr_b16 v[166:167], v13 offset:9216
    buffer_load_dword v157, v3, s[44:47], s63 offen offset:512 sc1
    v_mfma_f32_32x32x16_bf16 v[96:111], v[40:43], v[128:131], 0
    ds_read_b64_tr_b16 v[168:169], v14 offset:8192
    ds_read_b64_tr_b16 v[170:171], v14 offset:9216
    buffer_load_dword v158, v3, s[44:47], s63 offen offset:1024 sc1
    v_mfma_f32_32x32x16_bf16 v[112:127], v[44:47], v[128:131], 0
    ds_read_b64_tr_b16 v[172:173], v15 offset:8192
    ds_read_b64_tr_b16 v[174:175], v15 offset:9216
    buffer_load_dword v159, v3, s[44:47], s63 offen offset:1536 sc1
    s_add_u32 s63, s63, 4096
    s_waitcnt vmcnt(24) lgkmcnt(8)
    v_mfma_f32_32x32x16_bf16 v[64:79], v[48:51], v[132:135], v[64:79]
    ds_read_b64_tr_b16 v[32:33], v12 offset:12288
    ds_read_b64_tr_b16 v[34:35], v12 offset:13312
    buffer_load_dword v128, v3, s[44:47], s63 offen offset:0 sc1
    v_mfma_f32_32x32x16_bf16 v[80:95], v[52:55], v[132:135], v[80:95]
    ds_read_b64_tr_b16 v[36:37], v13 offset:12288
    ds_read_b64_tr_b16 v[38:39], v13 offset:13312
    buffer_load_dword v129, v3, s[44:47], s63 offen offset:512 sc1
    v_mfma_f32_32x32x16_bf16 v[96:111], v[56:59], v[132:135], v[96:111]
    ds_read_b64_tr_b16 v[40:41], v14 offset:12288
    ds_read_b64_tr_b16 v[42:43], v14 offset:13312
    buffer_load_dword v130, v3, s[44:47], s63 offen offset:1024 sc1
    v_mfma_f32_32x32x16_bf16 v[112:127], v[60:63], v[132:135], v[112:127]
    ds_read_b64_tr_b16 v[44:45], v15 offset:12288
    ds_read_b64_tr_b16 v[46:47], v15 offset:13312
    buffer_load_dword v131, v3, s[44:47], s63 offen offset:1536 sc1
    s_add_u32 s63, s63, 4096
    s_waitcnt vmcnt(24) lgkmcnt(8)
    v_mfma_f32_32x32x16_bf16 v[64:79], v[160:163], v[136:139], v[64:79]
    ds_read_b64_tr_b16 v[48:49], v12 offset:16384
    ds_read_b64_tr_b16 v[50:51], v12 offset:17408
    buffer_load_dword v132, v3, s[44:47], s63 offen offset:0 sc1
    v_mfma_f32_32x32x16_bf16 v[80:95], v[164:167], v[136:139], v[80:95]
    ds_read_b64_tr_b16 v[52:53], v13 offset:16384
    ds_read_b64_tr_b16 v[54:55], v13 offset:17408
    buffer_load_dword v133, v3, s[44:47], s63 offen offset:512 sc1
    v_mfma_f32_32x32x16_bf16 v[96:111], v[168:171], v[136:139], v[96:111]
    ds_read_b64_tr_b16 v[56:57], v14 offset:16384
    ds_read_b64_tr_b16 v[58:59], v14 offset:17408
    buffer_load_dword v134, v3, s[44:47], s63 offen offset:1024 sc1
    v_mfma_f32_32x32x16_bf16 v[112:127], v[172:175], v[136:139], v[112:127]
    ds_read_b64_tr_b16 v[60:61], v15 offset:16384
    ds_read_b64_tr_b16 v[62:63], v15 offset:17408
    buffer_load_dword v135, v3, s[44:47], s63 offen offset:1536 sc1
    s_add_u32 s63, s63, 4096
    s_waitcnt vmcnt(24) lgkmcnt(8)
    v_mfma_f32_32x32x16_bf16 v[64:79], v[32:35], v[140:143], v[64:79]
    ds_read_b64_tr_b16 v[160:161], v12 offset:20480
    ds_read_b64_tr_b16 v[162:163], v12 offset:21504
    buffer_load_dword v136, v3, s[44:47], s63 offen offset:0 sc1
    v_mfma_f32_32x32x16_bf16 v[80:95], v[36:39], v[140:143], v[80:95]
    ds_read_b64_tr_b16 v[164:165], v13 offset:20480
    ds_read_b64_tr_b16 v[166:167], v13 offset:21504
    buffer_load_dword v137, v3, s[44:47], s63 offen offset:512 sc1
    v_mfma_f32_32x32x16_bf16 v[96:111], v[40:43], v[140:143], v[96:111]
    ds_read_b64_tr_b16 v[168:169], v14 offset:20480
    ds_read_b64_tr_b16 v[170:171], v14 offset:21504
    buffer_load_dword v138, v3, s[44:47], s63 offen offset:1024 sc1
    v_mfma_f32_32x32x16_bf16 v[112:127], v[44:47], v[140:143], v[112:127]
    ds_read_b64_tr_b16 v[172:173], v15 offset:20480
    ds_read_b64_tr_b16 v[174:175], v15 offset:21504
    buffer_load_dword v139, v3, s[44:47], s63 offen offset:1536 sc1
    s_add_u32 s63, s63, 4096
    s_waitcnt vmcnt(24) lgkmcnt(8)
    v_mfma_f32_32x32x16_bf16 v[64:79], v[48:51], v[144:147], v[64:79]
    ds_read_b64_tr_b16 v[32:33], v12 offset:24576
    ds_read_b64_tr_b16 v[34:35], v12 offset:25600
    buffer_load_dword v140, v3, s[44:47], s63 offen offset:0 sc1
    v_mfma_f32_32x32x16_bf16 v[80:95], v[52:55], v[144:147], v[80:95]
    ds_read_b64_tr_b16 v[36:37], v13 offset:24576
    ds_read_b64_tr_b16 v[38:39], v13 offset:25600
    buffer_load_dword v141, v3, s[44:47], s63 offen offset:512 sc1
    v_mfma_f32_32x32x16_bf16 v[96:111], v[56:59], v[144:147], v[96:111]
    ds_read_b64_tr_b16 v[40:41], v14 offset:24576
    ds_read_b64_tr_b16 v[42:43], v14 offset:25600
    buffer_load_dword v142, v3, s[44:47], s63 offen offset:1024 sc1
    v_mfma_f32_32x32x16_bf16 v[112:127], v[60:63], v[144:147], v[112:127]
    ds_read_b64_tr_b16 v[44:45], v15 offset:24576
    ds_read_b64_tr_b16 v[46:47], v15 offset:25600
    buffer_load_dword v143, v3, s[44:47], s63 offen offset:1536 sc1
    s_add_u32 s63, s63, 4096
    s_waitcnt vmcnt(24) lgkmcnt(8)
    v_mfma_f32_32x32x16_bf16 v[64:79], v[160:163], v[148:151], v[64:79]
    ds_read_b64_tr_b16 v[48:49], v12 offset:28672
    ds_read_b64_tr_b16 v[50:51], v12 offset:29696
    buffer_load_dword v144, v3, s[44:47], s63 offen offset:0 sc1
    v_mfma_f32_32x32x16_bf16 v[80:95], v[164:167], v[148:151], v[80:95]
    ds_read_b64_tr_b16 v[52:53], v13 offset:28672
    ds_read_b64_tr_b16 v[54:55], v13 offset:29696
    buffer_load_dword v145, v3, s[44:47], s63 offen offset:512 sc1
    v_mfma_f32_32x32x16_bf16 v[96:111], v[168:171], v[148:151], v[96:111]
    ds_read_b64_tr_b16 v[56:57], v14 offset:28672
    ds_read_b64_tr_b16 v[58:59], v14 offset:29696
    buffer_load_dword v146, v3, s[44:47], s63 offen offset:1024 sc1
    v_mfma_f32_32x32x16_bf16 v[112:127], v[172:175], v[148:151], v[112:127]
    ds_read_b64_tr_b16 v[60:61], v15 offset:28672
    ds_read_b64_tr_b16 v[62:63], v15 offset:29696
    buffer_load_dword v147, v3, s[44:47], s63 offen offset:1536 sc1
    s_add_u32 s63, s63, 4096
    s_waitcnt vmcnt(24) lgkmcnt(8)
    v_mfma_f32_32x32x16_bf16 v[64:79], v[32:35], v[152:155], v[64:79]
    ds_read_b64_tr_b16 v[160:161], v12 offset:32768
    ds_read_b64_tr_b16 v[162:163], v12 offset:33792
    buffer_load_dword v148, v3, s[44:47], s63 offen offset:0 sc1
    v_mfma_f32_32x32x16_bf16 v[80:95], v[36:39], v[152:155], v[80:95]
    ds_read_b64_tr_b16 v[164:165], v13 offset:32768
    ds_read_b64_tr_b16 v[166:167], v13 offset:33792
    buffer_load_dword v149, v3, s[44:47], s63 offen offset:512 sc1
    v_mfma_f32_32x32x16_bf16 v[96:111], v[40:43], v[152:155], v[96:111]
    ds_read_b64_tr_b16 v[168:169], v14 offset:32768
    ds_read_b64_tr_b16 v[170:171], v14 offset:33792
    buffer_load_dword v150, v3, s[44:47], s63 offen offset:1024 sc1
    v_mfma_f32_32x32x16_bf16 v[112:127], v[44:47], v[152:155], v[112:127]
    ds_read_b64_tr_b16 v[172:173], v15 offset:32768
    ds_read_b64_tr_b16 v[174:175], v15 offset:33792
    buffer_load_dword v151, v3, s[44:47], s63 offen offset:1536 sc1
    s_add_u32 s63, s63, 4096
    s_waitcnt vmcnt(24) lgkmcnt(8)
    v_mfma_f32_32x32x16_bf16 v[64:79], v[48:51], v[156:159], v[64:79]
    ds_read_b64_tr_b16 v[32:33], v12 offset:36864
    ds_read_b64_tr_b16 v[34:35], v12 offset:37888
    buffer_load_dword v152, v3, s[44:47], s63 offen offset:0 sc1
    v_mfma_f32_32x32x16_bf16 v[80:95], v[52:55], v[156:159], v[80:95]
    ds_read_b64_tr_b16 v[36:37], v13 offset:36864
    ds_read_b64_tr_b16 v[38:39], v13 offset:37888
    buffer_load_dword v153, v3, s[44:47], s63 offen offset:512 sc1
    v_mfma_f32_32x32x16_bf16 v[96:111], v[56:59], v[156:159], v[96:111]
    ds_read_b64_tr_b16 v[40:41], v14 offset:36864
    ds_read_b64_tr_b16 v[42:43], v14 offset:37888
    buffer_load_dword v154, v3, s[44:47], s63 offen offset:1024 sc1
    v_mfma_f32_32x32x16_bf16 v[112:127], v[60:63], v[156:159], v[112:127]
    ds_read_b64_tr_b16 v[44:45], v15 offset:36864
    ds_read_b64_tr_b16 v[46:47], v15 offset:37888
    buffer_load_dword v155, v3, s[44:47], s63 offen offset:1536 sc1
    s_add_u32 s63, s63, 4096
    s_waitcnt vmcnt(24) lgkmcnt(8)
    v_mfma_f32_32x32x16_bf16 v[64:79], v[160:163], v[128:131], v[64:79]
    ds_read_b64_tr_b16 v[48:49], v12 offset:40960
    ds_read_b64_tr_b16 v[50:51], v12 offset:41984
    buffer_load_dword v156, v3, s[44:47], s63 offen offset:0 sc1
    v_mfma_f32_32x32x16_bf16 v[80:95], v[164:167], v[128:131], v[80:95]
    ds_read_b64_tr_b16 v[52:53], v13 offset:40960
    ds_read_b64_tr_b16 v[54:55], v13 offset:41984
    buffer_load_dword v157, v3, s[44:47], s63 offen offset:512 sc1
    v_mfma_f32_32x32x16_bf16 v[96:111], v[168:171], v[128:131], v[96:111]
    ds_read_b64_tr_b16 v[56:57], v14 offset:40960
    ds_read_b64_tr_b16 v[58:59], v14 offset:41984
    buffer_load_dword v158, v3, s[44:47], s63 offen offset:1024 sc1
    v_mfma_f32_32x32x16_bf16 v[112:127], v[172:175], v[128:131], v[112:127]
    ds_read_b64_tr_b16 v[60:61], v15 offset:40960
    ds_read_b64_tr_b16 v[62:63], v15 offset:41984
    buffer_load_dword v159, v3, s[44:47], s63 offen offset:1536 sc1
    s_add_u32 s63, s63, 4096
    s_waitcnt vmcnt(24) lgkmcnt(8)
    v_mfma_f32_32x32x16_bf16 v[64:79], v[32:35], v[132:135], v[64:79]
    ds_read_b64_tr_b16 v[160:161], v12 offset:45056
    ds_read_b64_tr_b16 v[162:163], v12 offset:46080
    buffer_load_dword v128, v3, s[44:47], s63 offen offset:0 sc1
    v_mfma_f32_32x32x16_bf16 v[80:95], v[36:39], v[132:135], v[80:95]
    ds_read_b64_tr_b16 v[164:165], v13 offset:45056
    ds_read_b64_tr_b16 v[166:167], v13 offset:46080
    buffer_load_dword v129, v3, s[44:47], s63 offen offset:512 sc1
    v_mfma_f32_32x32x16_bf16 v[96:111], v[40:43], v[132:135], v[96:111]
    ds_read_b64_tr_b16 v[168:169], v14 offset:45056
    ds_read_b64_tr_b16 v[170:171], v14 offset:46080
    buffer_load_dword v130, v3, s[44:47], s63 offen offset:1024 sc1
    v_mfma_f32_32x32x16_bf16 v[112:127], v[44:47], v[132:135], v[112:127]
    ds_read_b64_tr_b16 v[172:173], v15 offset:45056
    ds_read_b64_tr_b16 v[174:175], v15 offset:46080
    buffer_load_dword v131, v3, s[44:47], s63 offen offset:1536 sc1
    s_add_u32 s63, s63, 4096
    s_waitcnt vmcnt(24) lgkmcnt(8)
    v_mfma_f32_32x32x16_bf16 v[64:79], v[48:51], v[136:139], v[64:79]
    ds_read_b64_tr_b16 v[32:33], v12 offset:49152
    ds_read_b64_tr_b16 v[34:35], v12 offset:50176
    buffer_load_dword v132, v3, s[44:47], s63 offen offset:0 sc1
    v_mfma_f32_32x32x16_bf16 v[80:95], v[52:55], v[136:139], v[80:95]
    ds_read_b64_tr_b16 v[36:37], v13 offset:49152
    ds_read_b64_tr_b16 v[38:39], v13 offset:50176
    buffer_load_dword v133, v3, s[44:47], s63 offen offset:512 sc1
    v_mfma_f32_32x32x16_bf16 v[96:111], v[56:59], v[136:139], v[96:111]
    ds_read_b64_tr_b16 v[40:41], v14 offset:49152
    ds_read_b64_tr_b16 v[42:43], v14 offset:50176
    buffer_load_dword v134, v3, s[44:47], s63 offen offset:1024 sc1
    v_mfma_f32_32x32x16_bf16 v[112:127], v[60:63], v[136:139], v[112:127]
    ds_read_b64_tr_b16 v[44:45], v15 offset:49152
    ds_read_b64_tr_b16 v[46:47], v15 offset:50176
    buffer_load_dword v135, v3, s[44:47], s63 offen offset:1536 sc1
    s_add_u32 s63, s63, 4096
    s_waitcnt vmcnt(24) lgkmcnt(8)
    v_mfma_f32_32x32x16_bf16 v[64:79], v[160:163], v[140:143], v[64:79]
    ds_read_b64_tr_b16 v[48:49], v12 offset:53248
    ds_read_b64_tr_b16 v[50:51], v12 offset:54272
    buffer_load_dword v136, v3, s[44:47], s63 offen offset:0 sc1
    v_mfma_f32_32x32x16_bf16 v[80:95], v[164:167], v[140:143], v[80:95]
    ds_read_b64_tr_b16 v[52:53], v13 offset:53248
    ds_read_b64_tr_b16 v[54:55], v13 offset:54272
    buffer_load_dword v137, v3, s[44:47], s63 offen offset:512 sc1
    v_mfma_f32_32x32x16_bf16 v[96:111], v[168:171], v[140:143], v[96:111]
    ds_read_b64_tr_b16 v[56:57], v14 offset:53248
    ds_read_b64_tr_b16 v[58:59], v14 offset:54272
    buffer_load_dword v138, v3, s[44:47], s63 offen offset:1024 sc1
    v_mfma_f32_32x32x16_bf16 v[112:127], v[172:175], v[140:143], v[112:127]
    ds_read_b64_tr_b16 v[60:61], v15 offset:53248
    ds_read_b64_tr_b16 v[62:63], v15 offset:54272
    buffer_load_dword v139, v3, s[44:47], s63 offen offset:1536 sc1
    s_add_u32 s63, s63, 4096
    s_waitcnt vmcnt(24) lgkmcnt(8)
    v_mfma_f32_32x32x16_bf16 v[64:79], v[32:35], v[144:147], v[64:79]
    ds_read_b64_tr_b16 v[160:161], v12 offset:57344
    ds_read_b64_tr_b16 v[162:163], v12 offset:58368
    buffer_load_dword v140, v3, s[44:47], s63 offen offset:0 sc1
    v_mfma_f32_32x32x16_bf16 v[80:95], v[36:39], v[144:147], v[80:95]
    ds_read_b64_tr_b16 v[164:165], v13 offset:57344
    ds_read_b64_tr_b16 v[166:167], v13 offset:58368
    buffer_load_dword v141, v3, s[44:47], s63 offen offset:512 sc1
    v_mfma_f32_32x32x16_bf16 v[96:111], v[40:43], v[144:147], v[96:111]
    ds_read_b64_tr_b16 v[168:169], v14 offset:57344
    ds_read_b64_tr_b16 v[170:171], v14 offset:58368
    buffer_load_dword v142, v3, s[44:47], s63 offen offset:1024 sc1
    v_mfma_f32_32x32x16_bf16 v[112:127], v[44:47], v[144:147], v[112:127]
    ds_read_b64_tr_b16 v[172:173], v15 offset:57344
    ds_read_b64_tr_b16 v[174:175], v15 offset:58368
    buffer_load_dword v143, v3, s[44:47], s63 offen offset:1536 sc1
    s_add_u32 s63, s63, 4096
    s_waitcnt vmcnt(24) lgkmcnt(8)
    v_mfma_f32_32x32x16_bf16 v[64:79], v[48:51], v[148:151], v[64:79]
    ds_read_b64_tr_b16 v[32:33], v12 offset:61440
    ds_read_b64_tr_b16 v[34:35], v12 offset:62464
    buffer_load_dword v144, v3, s[44:47], s63 offen offset:0 sc1
    v_mfma_f32_32x32x16_bf16 v[80:95], v[52:55], v[148:151], v[80:95]
    ds_read_b64_tr_b16 v[36:37], v13 offset:61440
    ds_read_b64_tr_b16 v[38:39], v13 offset:62464
    buffer_load_dword v145, v3, s[44:47], s63 offen offset:512 sc1
    v_mfma_f32_32x32x16_bf16 v[96:111], v[56:59], v[148:151], v[96:111]
    ds_read_b64_tr_b16 v[40:41], v14 offset:61440
    ds_read_b64_tr_b16 v[42:43], v14 offset:62464
    buffer_load_dword v146, v3, s[44:47], s63 offen offset:1024 sc1
    v_mfma_f32_32x32x16_bf16 v[112:127], v[60:63], v[148:151], v[112:127]
    ds_read_b64_tr_b16 v[44:45], v15 offset:61440
    ds_read_b64_tr_b16 v[46:47], v15 offset:62464
    buffer_load_dword v147, v3, s[44:47], s63 offen offset:1536 sc1
    s_add_u32 s63, s63, 4096
    s_waitcnt vmcnt(24) lgkmcnt(8)
    buffer_load_dwordx2 v[180:181], v182, s[44:47], s68 offen sc1
    v_mfma_f32_32x32x16_bf16 v[64:79], v[160:163], v[152:155], v[64:79]
    ds_read_b64_tr_b16 v[48:49], v20 offset:0
    ds_read_b64_tr_b16 v[50:51], v20 offset:1024
    buffer_load_dword v148, v3, s[44:47], s63 offen offset:0 sc1
    v_mfma_f32_32x32x16_bf16 v[80:95], v[164:167], v[152:155], v[80:95]
    ds_read_b64_tr_b16 v[52:53], v21 offset:0
    ds_read_b64_tr_b16 v[54:55], v21 offset:1024
    buffer_load_dword v149, v3, s[44:47], s63 offen offset:512 sc1
    v_mfma_f32_32x32x16_bf16 v[96:111], v[168:171], v[152:155], v[96:111]
    ds_read_b64_tr_b16 v[56:57], v22 offset:0
    ds_read_b64_tr_b16 v[58:59], v22 offset:1024
    buffer_load_dword v150, v3, s[44:47], s63 offen offset:1024 sc1
    v_mfma_f32_32x32x16_bf16 v[112:127], v[172:175], v[152:155], v[112:127]
    ds_read_b64_tr_b16 v[60:61], v23 offset:0
    ds_read_b64_tr_b16 v[62:63], v23 offset:1024
    buffer_load_dword v151, v3, s[44:47], s63 offen offset:1536 sc1
    s_add_u32 s63, s63, 4096
    s_waitcnt vmcnt(25) lgkmcnt(8)
    v_mfma_f32_32x32x16_bf16 v[64:79], v[32:35], v[156:159], v[64:79]
    ds_read_b64_tr_b16 v[160:161], v20 offset:4096
    ds_read_b64_tr_b16 v[162:163], v20 offset:5120
    buffer_load_dword v152, v3, s[44:47], s63 offen offset:0 sc1
    v_mfma_f32_32x32x16_bf16 v[80:95], v[36:39], v[156:159], v[80:95]
    ds_read_b64_tr_b16 v[164:165], v21 offset:4096
    ds_read_b64_tr_b16 v[166:167], v21 offset:5120
    buffer_load_dword v153, v3, s[44:47], s63 offen offset:512 sc1
    v_mfma_f32_32x32x16_bf16 v[96:111], v[40:43], v[156:159], v[96:111]
    ds_read_b64_tr_b16 v[168:169], v22 offset:4096
    ds_read_b64_tr_b16 v[170:171], v22 offset:5120
    buffer_load_dword v154, v3, s[44:47], s63 offen offset:1024 sc1
    v_mfma_f32_32x32x16_bf16 v[112:127], v[44:47], v[156:159], v[112:127]
    ds_read_b64_tr_b16 v[172:173], v23 offset:4096
    ds_read_b64_tr_b16 v[174:175], v23 offset:5120
    buffer_load_dword v155, v3, s[44:47], s63 offen offset:1536 sc1
    s_add_u32 s63, s63, 4096
    s_waitcnt vmcnt(25) lgkmcnt(8)
    v_mfma_f32_32x32x16_bf16 v[64:79], v[48:51], v[128:131], v[64:79]
    ds_read_b64_tr_b16 v[32:33], v20 offset:8192
    ds_read_b64_tr_b16 v[34:35], v20 offset:9216
    buffer_load_dword v156, v3, s[44:47], s63 offen offset:0 sc1
    v_mfma_f32_32x32x16_bf16 v[80:95], v[52:55], v[128:131], v[80:95]
    ds_read_b64_tr_b16 v[36:37], v21 offset:8192
    ds_read_b64_tr_b16 v[38:39], v21 offset:9216
    buffer_load_dword v157, v3, s[44:47], s63 offen offset:512 sc1
    v_mfma_f32_32x32x16_bf16 v[96:111], v[56:59], v[128:131], v[96:111]
    ds_read_b64_tr_b16 v[40:41], v22 offset:8192
    ds_read_b64_tr_b16 v[42:43], v22 offset:9216
    buffer_load_dword v158, v3, s[44:47], s63 offen offset:1024 sc1
    v_mfma_f32_32x32x16_bf16 v[112:127], v[60:63], v[128:131], v[112:127]
    ds_read_b64_tr_b16 v[44:45], v23 offset:8192
    ds_read_b64_tr_b16 v[46:47], v23 offset:9216
    buffer_load_dword v159, v3, s[44:47], s63 offen offset:1536 sc1
    s_add_u32 s63, s63, 4096
    s_waitcnt vmcnt(25) lgkmcnt(8)
    v_mfma_f32_32x32x16_bf16 v[64:79], v[160:163], v[132:135], v[64:79]
    ds_read_b64_tr_b16 v[48:49], v20 offset:12288
    ds_read_b64_tr_b16 v[50:51], v20 offset:13312
    buffer_load_dword v128, v3, s[44:47], s63 offen offset:0 sc1
    v_mfma_f32_32x32x16_bf16 v[80:95], v[164:167], v[132:135], v[80:95]
    ds_read_b64_tr_b16 v[52:53], v21 offset:12288
    ds_read_b64_tr_b16 v[54:55], v21 offset:13312
    buffer_load_dword v129, v3, s[44:47], s63 offen offset:512 sc1
    v_mfma_f32_32x32x16_bf16 v[96:111], v[168:171], v[132:135], v[96:111]
    ds_read_b64_tr_b16 v[56:57], v22 offset:12288
    ds_read_b64_tr_b16 v[58:59], v22 offset:13312
    buffer_load_dword v130, v3, s[44:47], s63 offen offset:1024 sc1
    v_mfma_f32_32x32x16_bf16 v[112:127], v[172:175], v[132:135], v[112:127]
    ds_read_b64_tr_b16 v[60:61], v23 offset:12288
    ds_read_b64_tr_b16 v[62:63], v23 offset:13312
    buffer_load_dword v131, v3, s[44:47], s63 offen offset:1536 sc1
    s_add_u32 s63, s63, 4096
    s_waitcnt vmcnt(25) lgkmcnt(8)
    v_mfma_f32_32x32x16_bf16 v[64:79], v[32:35], v[136:139], v[64:79]
    ds_read_b64_tr_b16 v[160:161], v20 offset:16384
    ds_read_b64_tr_b16 v[162:163], v20 offset:17408
    buffer_load_dword v132, v3, s[44:47], s63 offen offset:0 sc1
    v_mfma_f32_32x32x16_bf16 v[80:95], v[36:39], v[136:139], v[80:95]
    ds_read_b64_tr_b16 v[164:165], v21 offset:16384
    ds_read_b64_tr_b16 v[166:167], v21 offset:17408
    buffer_load_dword v133, v3, s[44:47], s63 offen offset:512 sc1
    v_mfma_f32_32x32x16_bf16 v[96:111], v[40:43], v[136:139], v[96:111]
    ds_read_b64_tr_b16 v[168:169], v22 offset:16384
    ds_read_b64_tr_b16 v[170:171], v22 offset:17408
    buffer_load_dword v134, v3, s[44:47], s63 offen offset:1024 sc1
    v_mfma_f32_32x32x16_bf16 v[112:127], v[44:47], v[136:139], v[112:127]
    ds_read_b64_tr_b16 v[172:173], v23 offset:16384
    ds_read_b64_tr_b16 v[174:175], v23 offset:17408
    buffer_load_dword v135, v3, s[44:47], s63 offen offset:1536 sc1
    s_add_u32 s63, s63, 4096
    s_waitcnt vmcnt(25) lgkmcnt(8)
    v_mfma_f32_32x32x16_bf16 v[64:79], v[48:51], v[140:143], v[64:79]
    ds_read_b64_tr_b16 v[32:33], v20 offset:20480
    ds_read_b64_tr_b16 v[34:35], v20 offset:21504
    buffer_load_dword v136, v3, s[44:47], s63 offen offset:0 sc1
    v_mfma_f32_32x32x16_bf16 v[80:95], v[52:55], v[140:143], v[80:95]
    ds_read_b64_tr_b16 v[36:37], v21 offset:20480
    ds_read_b64_tr_b16 v[38:39], v21 offset:21504
    buffer_load_dword v137, v3, s[44:47], s63 offen offset:512 sc1
    v_mfma_f32_32x32x16_bf16 v[96:111], v[56:59], v[140:143], v[96:111]
    ds_read_b64_tr_b16 v[40:41], v22 offset:20480
    ds_read_b64_tr_b16 v[42:43], v22 offset:21504
    buffer_load_dword v138, v3, s[44:47], s63 offen offset:1024 sc1
    v_mfma_f32_32x32x16_bf16 v[112:127], v[60:63], v[140:143], v[112:127]
    ds_read_b64_tr_b16 v[44:45], v23 offset:20480
    ds_read_b64_tr_b16 v[46:47], v23 offset:21504
    buffer_load_dword v139, v3, s[44:47], s63 offen offset:1536 sc1
    s_add_u32 s63, s63, 4096
    s_waitcnt vmcnt(25) lgkmcnt(8)
    v_mfma_f32_32x32x16_bf16 v[64:79], v[160:163], v[144:147], v[64:79]
    ds_read_b64_tr_b16 v[48:49], v20 offset:24576
    ds_read_b64_tr_b16 v[50:51], v20 offset:25600
    buffer_load_dword v140, v3, s[44:47], s63 offen offset:0 sc1
    v_mfma_f32_32x32x16_bf16 v[80:95], v[164:167], v[144:147], v[80:95]
    ds_read_b64_tr_b16 v[52:53], v21 offset:24576
    ds_read_b64_tr_b16 v[54:55], v21 offset:25600
    buffer_load_dword v141, v3, s[44:47], s63 offen offset:512 sc1
    v_mfma_f32_32x32x16_bf16 v[96:111], v[168:171], v[144:147], v[96:111]
    ds_read_b64_tr_b16 v[56:57], v22 offset:24576
    ds_read_b64_tr_b16 v[58:59], v22 offset:25600
    buffer_load_dword v142, v3, s[44:47], s63 offen offset:1024 sc1
    v_mfma_f32_32x32x16_bf16 v[112:127], v[172:175], v[144:147], v[112:127]
    ds_read_b64_tr_b16 v[60:61], v23 offset:24576
    ds_read_b64_tr_b16 v[62:63], v23 offset:25600
    buffer_load_dword v143, v3, s[44:47], s63 offen offset:1536 sc1
    s_add_u32 s63, s63, 4096
    s_waitcnt vmcnt(24) lgkmcnt(8)
    v_mfma_f32_32x32x16_bf16 v[64:79], v[32:35], v[148:151], v[64:79]
    ds_read_b64_tr_b16 v[160:161], v20 offset:28672
    ds_read_b64_tr_b16 v[162:163], v20 offset:29696
    buffer_load_dword v144, v3, s[44:47], s63 offen offset:0 sc1
    v_mfma_f32_32x32x16_bf16 v[80:95], v[36:39], v[148:151], v[80:95]
    ds_read_b64_tr_b16 v[164:165], v21 offset:28672
    ds_read_b64_tr_b16 v[166:167], v21 offset:29696
    buffer_load_dword v145, v3, s[44:47], s63 offen offset:512 sc1
    v_mfma_f32_32x32x16_bf16 v[96:111], v[40:43], v[148:151], v[96:111]
    ds_read_b64_tr_b16 v[168:169], v22 offset:28672
    ds_read_b64_tr_b16 v[170:171], v22 offset:29696
    buffer_load_dword v146, v3, s[44:47], s63 offen offset:1024 sc1
    v_mfma_f32_32x32x16_bf16 v[112:127], v[44:47], v[148:151], v[112:127]
    ds_read_b64_tr_b16 v[172:173], v23 offset:28672
    ds_read_b64_tr_b16 v[174:175], v23 offset:29696
    buffer_load_dword v147, v3, s[44:47], s63 offen offset:1536 sc1
    s_add_u32 s63, s63, 4096
    s_waitcnt vmcnt(24) lgkmcnt(8)
    s_mov_b32 s83, 0
L_pollcs_9:
    v_cmp_ne_u32 vcc, s38, v181
    s_add_u32 s83, s83, 1
    s_cmp_ge_u32 s83, 65536
    s_cbranch_scc1 L_pollcs_done_10
    s_cbranch_vccz L_pollcs_done_10
    buffer_load_dwordx2 v[180:181], v182, s[44:47], s68 offen sc1
    s_waitcnt vmcnt(0)
    s_branch L_pollcs_9
L_pollcs_done_10:
    v_lshlrev_b32 v9, 16, v9
    v_cvt_pk_bf16_f32 v24, v180, v180
    v_lshlrev_b32 v8, 16, v24
    v_sub_f32 v8, v180, v8
    v_mov_b32 v27, 0
    v_lshlrev_b32 v5, 4, v0
    v_add_u32 v5, 131584, v5
    v_cvt_pk_bf16_f32 v25, v8, v9
    v_cvt_pk_bf16_f32 v26, v9, v27
    v_cmp_gt_u32 vcc, 128, v0
    s_nop 0
    s_and_saveexec_b64 s[72:73], vcc
    ds_write_b128 v5, v[24:27]
    s_mov_b64 exec, s[72:73]
    v_mfma_f32_32x32x16_bf16 v[64:79], v[48:51], v[152:155], v[64:79]
    ds_read_b64_tr_b16 v[32:33], v20 offset:32768
    ds_read_b64_tr_b16 v[34:35], v20 offset:33792
    buffer_load_dword v148, v3, s[44:47], s63 offen offset:0 sc1
    v_mfma_f32_32x32x16_bf16 v[80:95], v[52:55], v[152:155], v[80:95]
    ds_read_b64_tr_b16 v[36:37], v21 offset:32768
    ds_read_b64_tr_b16 v[38:39], v21 offset:33792
    buffer_load_dword v149, v3, s[44:47], s63 offen offset:512 sc1
    v_mfma_f32_32x32x16_bf16 v[96:111], v[56:59], v[152:155], v[96:111]
    ds_read_b64_tr_b16 v[40:41], v22 offset:32768
    ds_read_b64_tr_b16 v[42:43], v22 offset:33792
    buffer_load_dword v150, v3, s[44:47], s63 offen offset:1024 sc1
    v_mfma_f32_32x32x16_bf16 v[112:127], v[60:63], v[152:155], v[112:127]
    ds_read_b64_tr_b16 v[44:45], v23 offset:32768
    ds_read_b64_tr_b16 v[46:47], v23 offset:33792
    buffer_load_dword v151, v3, s[44:47], s63 offen offset:1536 sc1
    s_add_u32 s63, s63, 4096
    s_waitcnt vmcnt(24) lgkmcnt(8)
    v_mfma_f32_32x32x16_bf16 v[64:79], v[160:163], v[156:159], v[64:79]
    ds_read_b64_tr_b16 v[48:49], v20 offset:36864
    ds_read_b64_tr_b16 v[50:51], v20 offset:37888
    buffer_load_dword v152, v3, s[44:47], s63 offen offset:0 sc1
    v_mfma_f32_32x32x16_bf16 v[80:95], v[164:167], v[156:159], v[80:95]
    ds_read_b64_tr_b16 v[52:53], v21 offset:36864
    ds_read_b64_tr_b16 v[54:55], v21 offset:37888
    buffer_load_dword v153, v3, s[44:47], s63 offen offset:512 sc1
    v_mfma_f32_32x32x16_bf16 v[96:111], v[168:171], v[156:159], v[96:111]
    ds_read_b64_tr_b16 v[56:57], v22 offset:36864
    ds_read_b64_tr_b16 v[58:59], v22 offset:37888
    buffer_load_dword v154, v3, s[44:47], s63 offen offset:1024 sc1
    v_mfma_f32_32x32x16_bf16 v[112:127], v[172:175], v[156:159], v[112:127]
    ds_read_b64_tr_b16 v[60:61], v23 offset:36864
    ds_read_b64_tr_b16 v[62:63], v23 offset:37888
    buffer_load_dword v155, v3, s[44:47], s63 offen offset:1536 sc1
    s_add_u32 s63, s63, 4096
    s_waitcnt vmcnt(24) lgkmcnt(8)
    s_barrier
    v_and_b32 v5, 31, v1
    v_lshlrev_b32 v5, 4, v5
    s_mov_b32 exec_hi, 0
    s_add_u32 s64, s39, 0
    s_and_b32 s64, s64, 3
    s_lshl_b32 s64, s64, 9
    s_add_u32 s64, s64, 131584
    v_add_u32 v6, s64, v5
    ds_read_b128 v[192:195], v6
    s_add_u32 s64, s39, 1
    s_and_b32 s64, s64, 3
    s_lshl_b32 s64, s64, 9
    s_add_u32 s64, s64, 131584
    v_add_u32 v6, s64, v5
    ds_read_b128 v[196:199], v6
    s_add_u32 s64, s39, 2
    s_and_b32 s64, s64, 3
    s_lshl_b32 s64, s64, 9
    s_add_u32 s64, s64, 131584
    v_add_u32 v6, s64, v5
    ds_read_b128 v[200:203], v6
    s_add_u32 s64, s39, 3
    s_and_b32 s64, s64, 3
    s_lshl_b32 s64, s64, 9
    s_add_u32 s64, s64, 131584
    v_add_u32 v6, s64, v5
    ds_read_b128 v[204:207], v6
    s_mov_b32 exec_hi, -1
    v_mfma_f32_32x32x16_bf16 v[64:79], v[32:35], v[128:131], v[64:79]
    ds_read_b64_tr_b16 v[160:161], v20 offset:40960
    ds_read_b64_tr_b16 v[162:163], v20 offset:41984
    buffer_load_dword v156, v3, s[44:47], s63 offen offset:0 sc1
    v_mfma_f32_32x32x16_bf16 v[80:95], v[36:39], v[128:131], v[80:95]
    ds_read_b64_tr_b16 v[164:165], v21 offset:40960
    ds_read_b64_tr_b16 v[166:167], v21 offset:41984
    buffer_load_dword v157, v3, s[44:47], s63 offen offset:512 sc1
    v_mfma_f32_32x32x16_bf16 v[96:111], v[40:43], v[128:131], v[96:111]
    ds_read_b64_tr_b16 v[168:169], v22 offset:40960
    ds_read_b64_tr_b16 v[170:171], v22 offset:41984
    buffer_load_dword v158, v3, s[44:47], s63 offen offset:1024 sc1
    v_mfma_f32_32x32x16_bf16 v[112:127], v[44:47], v[128:131], v[112:127]
    ds_read_b64_tr_b16 v[172:173], v23 offset:40960
    ds_read_b64_tr_b16 v[174:175], v23 offset:41984
    buffer_load_dword v159, v3, s[44:47], s63 offen offset:1536 sc1
    s_add_u32 s63, s63, 4096
    s_waitcnt vmcnt(24) lgkmcnt(8)
    v_mfma_f32_32x32x16_bf16 v[64:79], v[48:51], v[132:135], v[64:79]
    ds_read_b64_tr_b16 v[32:33], v20 offset:45056
    ds_read_b64_tr_b16 v[34:35], v20 offset:46080
    v_mfma_f32_32x32x16_bf16 v[80:95], v[52:55], v[132:135], v[80:95]
    ds_read_b64_tr_b16 v[36:37], v21 offset:45056
    ds_read_b64_tr_b16 v[38:39], v21 offset:46080
    v_mfma_f32_32x32x16_bf16 v[96:111], v[56:59], v[132:135], v[96:111]
    ds_read_b64_tr_b16 v[40:41], v22 offset:45056
    ds_read_b64_tr_b16 v[42:43], v22 offset:46080
    v_mfma_f32_32x32x16_bf16 v[112:127], v[60:63], v[132:135], v[112:127]
    ds_read_b64_tr_b16 v[44:45], v23 offset:45056
    ds_read_b64_tr_b16 v[46:47], v23 offset:46080
    s_waitcnt vmcnt(20) lgkmcnt(8)
    v_mfma_f32_32x32x16_bf16 v[64:79], v[160:163], v[136:139], v[64:79]
    ds_read_b64_tr_b16 v[48:49], v20 offset:49152
    ds_read_b64_tr_b16 v[50:51], v20 offset:50176
    v_mfma_f32_32x32x16_bf16 v[80:95], v[164:167], v[136:139], v[80:95]
    ds_read_b64_tr_b16 v[52:53], v21 offset:49152
    ds_read_b64_tr_b16 v[54:55], v21 offset:50176
    v_mfma_f32_32x32x16_bf16 v[96:111], v[168:171], v[136:139], v[96:111]
    ds_read_b64_tr_b16 v[56:57], v22 offset:49152
    ds_read_b64_tr_b16 v[58:59], v22 offset:50176
    v_mfma_f32_32x32x16_bf16 v[112:127], v[172:175], v[136:139], v[112:127]
    ds_read_b64_tr_b16 v[60:61], v23 offset:49152
    ds_read_b64_tr_b16 v[62:63], v23 offset:50176
    s_waitcnt vmcnt(16) lgkmcnt(8)
    v_mfma_f32_32x32x16_bf16 v[64:79], v[32:35], v[140:143], v[64:79]
    ds_read_b64_tr_b16 v[160:161], v20 offset:53248
    ds_read_b64_tr_b16 v[162:163], v20 offset:54272
    v_mfma_f32_32x32x16_bf16 v[80:95], v[36:39], v[140:143], v[80:95]
    ds_read_b64_tr_b16 v[164:165], v21 offset:53248
    ds_read_b64_tr_b16 v[166:167], v21 offset:54272
    v_mfma_f32_32x32x16_bf16 v[96:111], v[40:43], v[140:143], v[96:111]
    ds_read_b64_tr_b16 v[168:169], v22 offset:53248
    ds_read_b64_tr_b16 v[170:171], v22 offset:54272
    buffer_load_dwordx4 v[176:179], v10, s[44:47], s66 offen sc1
    v_mfma_f32_32x32x16_bf16 v[112:127], v[44:47], v[140:143], v[112:127]
    ds_read_b64_tr_b16 v[172:173], v23 offset:53248
    ds_read_b64_tr_b16 v[174:175], v23 offset:54272
    s_waitcnt vmcnt(13) lgkmcnt(8)
    v_mfma_f32_32x32x16_bf16 v[64:79], v[48:51], v[144:147], v[64:79]
    ds_read_b64_tr_b16 v[32:33], v20 offset:57344
    ds_read_b64_tr_b16 v[34:35], v20 offset:58368
    v_mfma_f32_32x32x16_bf16 v[80:95], v[52:55], v[144:147], v[80:95]
    ds_read_b64_tr_b16 v[36:37], v21 offset:57344
    ds_read_b64_tr_b16 v[38:39], v21 offset:58368
    v_mfma_f32_32x32x16_bf16 v[96:111], v[56:59], v[144:147], v[96:111]
    ds_read_b64_tr_b16 v[40:41], v22 offset:57344
    ds_read_b64_tr_b16 v[42:43], v22 offset:58368
    v_mfma_f32_32x32x16_bf16 v[112:127], v[60:63], v[144:147], v[112:127]
    ds_read_b64_tr_b16 v[44:45], v23 offset:57344
    ds_read_b64_tr_b16 v[46:47], v23 offset:58368
    s_waitcnt vmcnt(9) lgkmcnt(8)
    v_mfma_f32_32x32x16_bf16 v[64:79], v[160:163], v[148:151], v[64:79]
    ds_read_b64_tr_b16 v[48:49], v20 offset:61440
    ds_read_b64_tr_b16 v[50:51], v20 offset:62464
    v_mfma_f32_32x32x16_bf16 v[80:95], v[164:167], v[148:151], v[80:95]
    ds_read_b64_tr_b16 v[52:53], v21 offset:61440
    ds_read_b64_tr_b16 v[54:55], v21 offset:62464
    v_mfma_f32_32x32x16_bf16 v[96:111], v[168:171], v[148:151], v[96:111]
    ds_read_b64_tr_b16 v[56:57], v22 offset:61440
    ds_read_b64_tr_b16 v[58:59], v22 offset:62464
    v_mfma_f32_32x32x16_bf16 v[112:127], v[172:175], v[148:151], v[112:127]
    ds_read_b64_tr_b16 v[60:61], v23 offset:61440
    ds_read_b64_tr_b16 v[62:63], v23 offset:62464
    s_waitcnt vmcnt(5) lgkmcnt(8)
    v_mfma_f32_32x32x16_bf16 v[64:79], v[32:35], v[152:155], v[64:79]
    v_mfma_f32_32x32x16_bf16 v[80:95], v[36:39], v[152:155], v[80:95]
    v_mfma_f32_32x32x16_bf16 v[96:111], v[40:43], v[152:155], v[96:111]
    v_mfma_f32_32x32x16_bf16 v[112:127], v[44:47], v[152:155], v[112:127]
    s_waitcnt vmcnt(1) lgkmcnt(0)
    v_mfma_f32_32x32x16_bf16 v[64:79], v[48:51], v[156:159], v[64:79]
    v_mfma_f32_32x32x16_bf16 v[80:95], v[52:55], v[156:159], v[80:95]
    v_mfma_f32_32x32x16_bf16 v[96:111], v[56:59], v[156:159], v[96:111]
    v_mfma_f32_32x32x16_bf16 v[112:127], v[60:63], v[156:159], v[112:127]
    s_mov_b32 s83, 0
    s_branch L_pollg_first_13
L_pollg_11:
    buffer_load_dwordx4 v[176:179], v10, s[44:47], s66 offen sc1
L_pollg_first_13:
    s_waitcnt vmcnt(0)
    v_xor_b32 v26, s38, v177
    v_xor_b32 v27, s38, v179
    v_or_b32 v26, v26, v27
    v_cmp_ne_u32 vcc, 0, v26
    s_add_u32 s83, s83, 1
    s_cmp_ge_u32 s83, 65536
    s_cbranch_scc1 L_pollg_done_12
    s_cbranch_vccnz L_pollg_11
L_pollg_done_12:
    v_sub_f32 v2, 0, v178
    v_rcp_f32 v7, v176
    v_cvt_pk_bf16_f32 v25, v2, v176
    v_mov_b32 v27, 0
    v_lshlrev_b32 v4, 16, v25
    v_and_b32 v6, 0xffff0000, v25
    v_sub_f32 v4, v2, v4
    v_sub_f32 v6, v176, v6
    v_cvt_pk_bf16_f32 v24, v2, v4
    v_cvt_pk_bf16_f32 v26, v6, v27
    s_nop 1
    v_mfma_f32_32x32x16_bf16 v[64:79], v[192:195], v[24:27], v[64:79]
    v_mfma_f32_32x32x16_bf16 v[80:95], v[196:199], v[24:27], v[80:95]
    v_mfma_f32_32x32x16_bf16 v[96:111], v[200:203], v[24:27], v[96:111]
    v_mfma_f32_32x32x16_bf16 v[112:127], v[204:207], v[24:27], v[112:127]
    v_mul_f32 v28, 0xc0135761, v7
    v_mul_f32 v29, v7, v7
    v_mul_f32 v29, v29, v28
    v_mul_f32 v29, 0x3d372713, v29
    s_barrier
    v_lshlrev_b32 v3, 4, v1
    s_lshl_b32 s62, s60, 2
    s_add_u32 s62, s62, s39
    s_mul_i32 s62, s62, 114688
    s_lshl_b32 s63, s61, 13
    s_add_u32 s62, s62, s63
    s_add_u32 s62, s62, 4194304
    s_add_u32 s70, s39, 0
    s_and_b32 s70, s70, 3
    s_lshl_b32 s70, s70, 11
    s_add_u32 s70, s70, s62
    v_pk_mul_f32 v[128:129], v[64:65], v[64:65]
    v_pk_mul_f32 v[130:131], v[66:67], v[66:67]
    v_pk_mul_f32 v[132:133], v[68:69], v[68:69]
    v_pk_mul_f32 v[134:135], v[70:71], v[70:71]
    v_pk_mul_f32 v[136:137], v[72:73], v[72:73]
    v_pk_mul_f32 v[138:139], v[74:75], v[74:75]
    v_pk_mul_f32 v[140:141], v[76:77], v[76:77]
    v_pk_mul_f32 v[142:143], v[78:79], v[78:79]
    v_pk_fma_f32 v[128:129], v[128:129], v[28:29], v[28:29] op_sel:[0,1,0] op_sel_hi:[1,1,0]
    v_pk_fma_f32 v[130:131], v[130:131], v[28:29], v[28:29] op_sel:[0,1,0] op_sel_hi:[1,1,0]
    v_pk_fma_f32 v[132:133], v[132:133], v[28:29], v[28:29] op_sel:[0,1,0] op_sel_hi:[1,1,0]
    v_pk_fma_f32 v[134:135], v[134:135], v[28:29], v[28:29] op_sel:[0,1,0] op_sel_hi:[1,1,0]
    v_pk_fma_f32 v[136:137], v[136:137], v[28:29], v[28:29] op_sel:[0,1,0] op_sel_hi:[1,1,0]
    v_pk_fma_f32 v[138:139], v[138:139], v[28:29], v[28:29] op_sel:[0,1,0] op_sel_hi:[1,1,0]
    v_pk_fma_f32 v[140:141], v[140:141], v[28:29], v[28:29] op_sel:[0,1,0] op_sel_hi:[1,1,0]
    v_pk_fma_f32 v[142:143], v[142:143], v[28:29], v[28:29] op_sel:[0,1,0] op_sel_hi:[1,1,0]
    v_pk_mul_f32 v[128:129], v[128:129], v[64:65]
    v_pk_mul_f32 v[130:131], v[130:131], v[66:67]
    v_pk_mul_f32 v[132:133], v[132:133], v[68:69]
    v_pk_mul_f32 v[134:135], v[134:135], v[70:71]
    v_pk_mul_f32 v[136:137], v[136:137], v[72:73]
    v_pk_mul_f32 v[138:139], v[138:139], v[74:75]
    v_pk_mul_f32 v[140:141], v[140:141], v[76:77]
    v_pk_mul_f32 v[142:143], v[142:143], v[78:79]
    v_exp_f32 v128, v128
    v_exp_f32 v129, v129
    s_mul_i32 s89, s39, 32768
    s_add_u32 s89, s89, 0
    s_mov_b32 m0, s89
    s_add_u32 s89, s89, 2048
    buffer_load_dwordx4 v16, s[52:55], s90 offen lds
    v_exp_f32 v130, v130
    v_exp_f32 v131, v131
    v_exp_f32 v132, v132
    v_exp_f32 v133, v133
    v_exp_f32 v134, v134
    v_exp_f32 v135, v135
    v_exp_f32 v136, v136
    v_exp_f32 v137, v137
    v_exp_f32 v138, v138
    v_exp_f32 v139, v139
    v_exp_f32 v140, v140
    v_exp_f32 v141, v141
    v_exp_f32 v142, v142
    v_exp_f32 v143, v143
    v_pk_add_f32 v[128:129], v[128:129], 1.0 op_sel_hi:[1,0]
    v_pk_add_f32 v[130:131], v[130:131], 1.0 op_sel_hi:[1,0]
    v_pk_add_f32 v[132:133], v[132:133], 1.0 op_sel_hi:[1,0]
    v_pk_add_f32 v[134:135], v[134:135], 1.0 op_sel_hi:[1,0]
    v_pk_add_f32 v[136:137], v[136:137], 1.0 op_sel_hi:[1,0]
    v_pk_add_f32 v[138:139], v[138:139], 1.0 op_sel_hi:[1,0]
    v_pk_add_f32 v[140:141], v[140:141], 1.0 op_sel_hi:[1,0]
    v_pk_add_f32 v[142:143], v[142:143], 1.0 op_sel_hi:[1,0]
    v_rcp_f32 v128, v128
    v_rcp_f32 v129, v129
    v_rcp_f32 v130, v130
    buffer_load_dwordx4 v19, s[52:55], s90 offen offset:1024 lds
    s_add_u32 s90, s90, 16384
    s_cmp_ge_u32 s90, 458752
    s_cselect_b32 s91, 458752, 0
    s_sub_u32 s90, s90, s91
    v_rcp_f32 v131, v131
    v_rcp_f32 v132, v132
    v_rcp_f32 v133, v133
    v_rcp_f32 v134, v134
    v_rcp_f32 v135, v135
    v_rcp_f32 v136, v136
    v_rcp_f32 v137, v137
    v_rcp_f32 v138, v138
    v_rcp_f32 v139, v139
    v_rcp_f32 v140, v140
    v_rcp_f32 v141, v141
    v_rcp_f32 v142, v142
    v_rcp_f32 v143, v143
    v_pk_mul_f32 v[128:129], v[128:129], v[64:65]
    v_pk_mul_f32 v[130:131], v[130:131], v[66:67]
    v_pk_mul_f32 v[132:133], v[132:133], v[68:69]
    v_pk_mul_f32 v[134:135], v[134:135], v[70:71]
    v_pk_mul_f32 v[136:137], v[136:137], v[72:73]
    v_pk_mul_f32 v[138:139], v[138:139], v[74:75]
    v_pk_mul_f32 v[140:141], v[140:141], v[76:77]
    v_pk_mul_f32 v[142:143], v[142:143], v[78:79]
    v_cvt_pk_bf16_f32 v160, v128, v129
    v_cvt_pk_bf16_f32 v161, v130, v131
    v_cvt_pk_bf16_f32 v162, v132, v133
    v_cvt_pk_bf16_f32 v163, v134, v135
    v_cvt_pk_bf16_f32 v164, v136, v137
    s_mov_b32 m0, s89
    s_add_u32 s89, s89, 2048
    buffer_load_dwordx4 v16, s[52:55], s90 offen lds
    v_cvt_pk_bf16_f32 v165, v138, v139
    v_cvt_pk_bf16_f32 v166, v140, v141
    v_cvt_pk_bf16_f32 v167, v142, v143
    buffer_store_dwordx4 v[160:163], v3, s[44:47], s70 offen sc1
    buffer_store_dwordx4 v[164:167], v3, s[44:47], s70 offen offset:1024 sc1
    s_add_u32 s70, s39, 1
    s_and_b32 s70, s70, 3
    s_lshl_b32 s70, s70, 11
    s_add_u32 s70, s70, s62
    v_pk_mul_f32 v[144:145], v[80:81], v[80:81]
    v_pk_mul_f32 v[146:147], v[82:83], v[82:83]
    v_pk_mul_f32 v[148:149], v[84:85], v[84:85]
    v_pk_mul_f32 v[150:151], v[86:87], v[86:87]
    v_pk_mul_f32 v[152:153], v[88:89], v[88:89]
    v_pk_mul_f32 v[154:155], v[90:91], v[90:91]
    v_pk_mul_f32 v[156:157], v[92:93], v[92:93]
    v_pk_mul_f32 v[158:159], v[94:95], v[94:95]
    v_pk_fma_f32 v[144:145], v[144:145], v[28:29], v[28:29] op_sel:[0,1,0] op_sel_hi:[1,1,0]
    v_pk_fma_f32 v[146:147], v[146:147], v[28:29], v[28:29] op_sel:[0,1,0] op_sel_hi:[1,1,0]
    v_pk_fma_f32 v[148:149], v[148:149], v[28:29], v[28:29] op_sel:[0,1,0] op_sel_hi:[1,1,0]
    v_pk_fma_f32 v[150:151], v[150:151], v[28:29], v[28:29] op_sel:[0,1,0] op_sel_hi:[1,1,0]
    v_pk_fma_f32 v[152:153], v[152:153], v[28:29], v[28:29] op_sel:[0,1,0] op_sel_hi:[1,1,0]
    v_pk_fma_f32 v[154:155], v[154:155], v[28:29], v[28:29] op_sel:[0,1,0] op_sel_hi:[1,1,0]
    v_pk_fma_f32 v[156:157], v[156:157], v[28:29], v[28:29] op_sel:[0,1,0] op_sel_hi:[1,1,0]
    v_pk_fma_f32 v[158:159], v[158:159], v[28:29], v[28:29] op_sel:[0,1,0] op_sel_hi:[1,1,0]
    buffer_load_dwordx4 v19, s[52:55], s90 offen offset:1024 lds
    s_add_u32 s90, s90, 16384
    s_cmp_ge_u32 s90, 458752
    s_cselect_b32 s91, 458752, 0
    s_sub_u32 s90, s90, s91
    v_pk_mul_f32 v[144:145], v[144:145], v[80:81]
    v_pk_mul_f32 v[146:147], v[146:147], v[82:83]
    v_pk_mul_f32 v[148:149], v[148:149], v[84:85]
    v_pk_mul_f32 v[150:151], v[150:151], v[86:87]
    v_pk_mul_f32 v[152:153], v[152:153], v[88:89]
    v_pk_mul_f32 v[154:155], v[154:155], v[90:91]
    v_pk_mul_f32 v[156:157], v[156:157], v[92:93]
    v_pk_mul_f32 v[158:159], v[158:159], v[94:95]
    v_exp_f32 v144, v144
    v_exp_f32 v145, v145
    v_exp_f32 v146, v146
    v_exp_f32 v147, v147
    v_exp_f32 v148, v148
    v_exp_f32 v149, v149
    v_exp_f32 v150, v150
    v_exp_f32 v151, v151
    v_exp_f32 v152, v152
    v_exp_f32 v153, v153
    v_exp_f32 v154, v154
    v_exp_f32 v155, v155
    v_exp_f32 v156, v156
    v_exp_f32 v157, v157
    v_exp_f32 v158, v158
    v_exp_f32 v159, v159
    v_pk_add_f32 v[144:145], v[144:145], 1.0 op_sel_hi:[1,0]
    v_pk_add_f32 v[146:147], v[146:147], 1.0 op_sel_hi:[1,0]
    s_mov_b32 m0, s89
    s_add_u32 s89, s89, 2048
    buffer_load_dwordx4 v16, s[52:55], s90 offen lds
    v_pk_add_f32 v[148:149], v[148:149], 1.0 op_sel_hi:[1,0]
    v_pk_add_f32 v[150:151], v[150:151], 1.0 op_sel_hi:[1,0]
    v_pk_add_f32 v[152:153], v[152:153], 1.0 op_sel_hi:[1,0]
    v_pk_add_f32 v[154:155], v[154:155], 1.0 op_sel_hi:[1,0]
    v_pk_add_f32 v[156:157], v[156:157], 1.0 op_sel_hi:[1,0]
    v_pk_add_f32 v[158:159], v[158:159], 1.0 op_sel_hi:[1,0]
    v_rcp_f32 v144, v144
    v_rcp_f32 v145, v145
    v_rcp_f32 v146, v146
    v_rcp_f32 v147, v147
    v_rcp_f32 v148, v148
    v_rcp_f32 v149, v149
    v_rcp_f32 v150, v150
    v_rcp_f32 v151, v151
    v_rcp_f32 v152, v152
    v_rcp_f32 v153, v153
    v_rcp_f32 v154, v154
    v_rcp_f32 v155, v155
    v_rcp_f32 v156, v156
    v_rcp_f32 v157, v157
    v_rcp_f32 v158, v158
    v_rcp_f32 v159, v159
    v_pk_mul_f32 v[144:145], v[144:145], v[80:81]
    v_pk_mul_f32 v[146:147], v[146:147], v[82:83]
    v_pk_mul_f32 v[148:149], v[148:149], v[84:85]
    buffer_load_dwordx4 v19, s[52:55], s90 offen offset:1024 lds
    s_add_u32 s90, s90, 16384
    s_cmp_ge_u32 s90, 458752
    s_cselect_b32 s91, 458752, 0
    s_sub_u32 s90, s90, s91
    v_pk_mul_f32 v[150:151], v[150:151], v[86:87]
    v_pk_mul_f32 v[152:153], v[152:153], v[88:89]
    v_pk_mul_f32 v[154:155], v[154:155], v[90:91]
    v_pk_mul_f32 v[156:157], v[156:157], v[92:93]
    v_pk_mul_f32 v[158:159], v[158:159], v[94:95]
    v_cvt_pk_bf16_f32 v168, v144, v145
    v_cvt_pk_bf16_f32 v169, v146, v147
    v_cvt_pk_bf16_f32 v170, v148, v149
    v_cvt_pk_bf16_f32 v171, v150, v151
    v_cvt_pk_bf16_f32 v172, v152, v153
    v_cvt_pk_bf16_f32 v173, v154, v155
    v_cvt_pk_bf16_f32 v174, v156, v157
    v_cvt_pk_bf16_f32 v175, v158, v159
    buffer_store_dwordx4 v[168:171], v3, s[44:47], s70 offen sc1
    buffer_store_dwordx4 v[172:175], v3, s[44:47], s70 offen offset:1024 sc1
    s_add_u32 s70, s39, 2
    s_and_b32 s70, s70, 3
    s_lshl_b32 s70, s70, 11
    s_add_u32 s70, s70, s62
    v_pk_mul_f32 v[128:129], v[96:97], v[96:97]
    v_pk_mul_f32 v[130:131], v[98:99], v[98:99]
    v_pk_mul_f32 v[132:133], v[100:101], v[100:101]
    v_pk_mul_f32 v[134:135], v[102:103], v[102:103]
    v_pk_mul_f32 v[136:137], v[104:105], v[104:105]
    v_pk_mul_f32 v[138:139], v[106:107], v[106:107]
    s_mov_b32 m0, s89
    s_add_u32 s89, s89, 2048
    buffer_load_dwordx4 v16, s[52:55], s90 offen lds
    v_pk_mul_f32 v[140:141], v[108:109], v[108:109]
    v_pk_mul_f32 v[142:143], v[110:111], v[110:111]
    v_pk_fma_f32 v[128:129], v[128:129], v[28:29], v[28:29] op_sel:[0,1,0] op_sel_hi:[1,1,0]
    v_pk_fma_f32 v[130:131], v[130:131], v[28:29], v[28:29] op_sel:[0,1,0] op_sel_hi:[1,1,0]
    v_pk_fma_f32 v[132:133], v[132:133], v[28:29], v[28:29] op_sel:[0,1,0] op_sel_hi:[1,1,0]
    v_pk_fma_f32 v[134:135], v[134:135], v[28:29], v[28:29] op_sel:[0,1,0] op_sel_hi:[1,1,0]
    v_pk_fma_f32 v[136:137], v[136:137], v[28:29], v[28:29] op_sel:[0,1,0] op_sel_hi:[1,1,0]
    v_pk_fma_f32 v[138:139], v[138:139], v[28:29], v[28:29] op_sel:[0,1,0] op_sel_hi:[1,1,0]
    v_pk_fma_f32 v[140:141], v[140:141], v[28:29], v[28:29] op_sel:[0,1,0] op_sel_hi:[1,1,0]
    v_pk_fma_f32 v[142:143], v[142:143], v[28:29], v[28:29] op_sel:[0,1,0] op_sel_hi:[1,1,0]
    v_pk_mul_f32 v[128:129], v[128:129], v[96:97]
    v_pk_mul_f32 v[130:131], v[130:131], v[98:99]
    v_pk_mul_f32 v[132:133], v[132:133], v[100:101]
    v_pk_mul_f32 v[134:135], v[134:135], v[102:103]
    v_pk_mul_f32 v[136:137], v[136:137], v[104:105]
    v_pk_mul_f32 v[138:139], v[138:139], v[106:107]
    v_pk_mul_f32 v[140:141], v[140:141], v[108:109]
    v_pk_mul_f32 v[142:143], v[142:143], v[110:111]
    v_exp_f32 v128, v128
    v_exp_f32 v129, v129
    v_exp_f32 v130, v130
    v_exp_f32 v131, v131
    v_exp_f32 v132, v132
    v_exp_f32 v133, v133
    v_exp_f32 v134, v134
    v_exp_f32 v135, v135
    buffer_load_dwordx4 v19, s[52:55], s90 offen offset:1024 lds
    s_add_u32 s90, s90, 16384
    s_cmp_ge_u32 s90, 458752
    s_cselect_b32 s91, 458752, 0
    s_sub_u32 s90, s90, s91
    v_exp_f32 v136, v136
    v_exp_f32 v137, v137
    v_exp_f32 v138, v138
    v_exp_f32 v139, v139
    v_exp_f32 v140, v140
    v_exp_f32 v141, v141
    v_exp_f32 v142, v142
    v_exp_f32 v143, v143
    v_pk_add_f32 v[128:129], v[128:129], 1.0 op_sel_hi:[1,0]
    v_pk_add_f32 v[130:131], v[130:131], 1.0 op_sel_hi:[1,0]
    v_pk_add_f32 v[132:133], v[132:133], 1.0 op_sel_hi:[1,0]
    v_pk_add_f32 v[134:135], v[134:135], 1.0 op_sel_hi:[1,0]
    v_pk_add_f32 v[136:137], v[136:137], 1.0 op_sel_hi:[1,0]
    v_pk_add_f32 v[138:139], v[138:139], 1.0 op_sel_hi:[1,0]
    v_pk_add_f32 v[140:141], v[140:141], 1.0 op_sel_hi:[1,0]
    v_pk_add_f32 v[142:143], v[142:143], 1.0 op_sel_hi:[1,0]
    v_rcp_f32 v128, v128
    v_rcp_f32 v129, v129
    v_rcp_f32 v130, v130
    v_rcp_f32 v131, v131
    v_rcp_f32 v132, v132
    v_rcp_f32 v133, v133
    v_rcp_f32 v134, v134
    v_rcp_f32 v135, v135
    v_rcp_f32 v136, v136
    s_mov_b32 m0, s89
    s_add_u32 s89, s89, 2048
    buffer_load_dwordx4 v16, s[52:55], s90 offen lds
    v_rcp_f32 v137, v137
    v_rcp_f32 v138, v138
    v_rcp_f32 v139, v139
    v_rcp_f32 v140, v140
    v_rcp_f32 v141, v141
    v_rcp_f32 v142, v142
    v_rcp_f32 v143, v143
    v_pk_mul_f32 v[128:129], v[128:129], v[96:97]
    v_pk_mul_f32 v[130:131], v[130:131], v[98:99]
    v_pk_mul_f32 v[132:133], v[132:133], v[100:101]
    v_pk_mul_f32 v[134:135], v[134:135], v[102:103]
    v_pk_mul_f32 v[136:137], v[136:137], v[104:105]
    v_pk_mul_f32 v[138:139], v[138:139], v[106:107]
    v_pk_mul_f32 v[140:141], v[140:141], v[108:109]
    v_pk_mul_f32 v[142:143], v[142:143], v[110:111]
    v_cvt_pk_bf16_f32 v176, v128, v129
    v_cvt_pk_bf16_f32 v177, v130, v131
    v_cvt_pk_bf16_f32 v178, v132, v133
    v_cvt_pk_bf16_f32 v179, v134, v135
    v_cvt_pk_bf16_f32 v180, v136, v137
    v_cvt_pk_bf16_f32 v181, v138, v139
    v_cvt_pk_bf16_f32 v182, v140, v141
    v_cvt_pk_bf16_f32 v183, v142, v143
    buffer_store_dwordx4 v[176:179], v3, s[44:47], s70 offen sc1
    buffer_store_dwordx4 v[180:183], v3, s[44:47], s70 offen offset:1024 sc1
    s_add_u32 s70, s39, 3
    buffer_load_dwordx4 v19, s[52:55], s90 offen offset:1024 lds
    s_add_u32 s90, s90, 16384
    s_cmp_ge_u32 s90, 458752
    s_cselect_b32 s91, 458752, 0
    s_sub_u32 s90, s90, s91
    s_and_b32 s70, s70, 3
    s_lshl_b32 s70, s70, 11
    s_add_u32 s70, s70, s62
    v_pk_mul_f32 v[144:145], v[112:113], v[112:113]
    v_pk_mul_f32 v[146:147], v[114:115], v[114:115]
    v_pk_mul_f32 v[148:149], v[116:117], v[116:117]
    v_pk_mul_f32 v[150:151], v[118:119], v[118:119]
    v_pk_mul_f32 v[152:153], v[120:121], v[120:121]
    v_pk_mul_f32 v[154:155], v[122:123], v[122:123]
    v_pk_mul_f32 v[156:157], v[124:125], v[124:125]
    v_pk_mul_f32 v[158:159], v[126:127], v[126:127]
    v_pk_fma_f32 v[144:145], v[144:145], v[28:29], v[28:29] op_sel:[0,1,0] op_sel_hi:[1,1,0]
    v_pk_fma_f32 v[146:147], v[146:147], v[28:29], v[28:29] op_sel:[0,1,0] op_sel_hi:[1,1,0]
    v_pk_fma_f32 v[148:149], v[148:149], v[28:29], v[28:29] op_sel:[0,1,0] op_sel_hi:[1,1,0]
    v_pk_fma_f32 v[150:151], v[150:151], v[28:29], v[28:29] op_sel:[0,1,0] op_sel_hi:[1,1,0]
    v_pk_fma_f32 v[152:153], v[152:153], v[28:29], v[28:29] op_sel:[0,1,0] op_sel_hi:[1,1,0]
    v_pk_fma_f32 v[154:155], v[154:155], v[28:29], v[28:29] op_sel:[0,1,0] op_sel_hi:[1,1,0]
    v_pk_fma_f32 v[156:157], v[156:157], v[28:29], v[28:29] op_sel:[0,1,0] op_sel_hi:[1,1,0]
    v_pk_fma_f32 v[158:159], v[158:159], v[28:29], v[28:29] op_sel:[0,1,0] op_sel_hi:[1,1,0]
    v_pk_mul_f32 v[144:145], v[144:145], v[112:113]
    v_pk_mul_f32 v[146:147], v[146:147], v[114:115]
    v_pk_mul_f32 v[148:149], v[148:149], v[116:117]
    v_pk_mul_f32 v[150:151], v[150:151], v[118:119]
    v_pk_mul_f32 v[152:153], v[152:153], v[120:121]
    v_pk_mul_f32 v[154:155], v[154:155], v[122:123]
    s_mov_b32 m0, s89
    s_add_u32 s89, s89, 2048
    buffer_load_dwordx4 v16, s[52:55], s90 offen lds
    v_pk_mul_f32 v[156:157], v[156:157], v[124:125]
    v_pk_mul_f32 v[158:159], v[158:159], v[126:127]
    v_exp_f32 v144, v144
    v_exp_f32 v145, v145
    v_exp_f32 v146, v146
    v_exp_f32 v147, v147
    v_exp_f32 v148, v148
    v_exp_f32 v149, v149
    v_exp_f32 v150, v150
    v_exp_f32 v151, v151
    v_exp_f32 v152, v152
    v_exp_f32 v153, v153
    v_exp_f32 v154, v154
    v_exp_f32 v155, v155
    v_exp_f32 v156, v156
    v_exp_f32 v157, v157
    v_exp_f32 v158, v158
    v_exp_f32 v159, v159
    v_pk_add_f32 v[144:145], v[144:145], 1.0 op_sel_hi:[1,0]
    v_pk_add_f32 v[146:147], v[146:147], 1.0 op_sel_hi:[1,0]
    v_pk_add_f32 v[148:149], v[148:149], 1.0 op_sel_hi:[1,0]
    v_pk_add_f32 v[150:151], v[150:151], 1.0 op_sel_hi:[1,0]
    v_pk_add_f32 v[152:153], v[152:153], 1.0 op_sel_hi:[1,0]
    v_pk_add_f32 v[154:155], v[154:155], 1.0 op_sel_hi:[1,0]
    v_pk_add_f32 v[156:157], v[156:157], 1.0 op_sel_hi:[1,0]
    buffer_load_dwordx4 v19, s[52:55], s90 offen offset:1024 lds
    s_add_u32 s90, s90, 16384
    s_cmp_ge_u32 s90, 458752
    s_cselect_b32 s91, 458752, 0
    s_sub_u32 s90, s90, s91
    v_pk_add_f32 v[158:159], v[158:159], 1.0 op_sel_hi:[1,0]
    v_rcp_f32 v144, v144
    v_rcp_f32 v145, v145
    v_rcp_f32 v146, v146
    v_rcp_f32 v147, v147
    v_rcp_f32 v148, v148
    v_rcp_f32 v149, v149
    v_rcp_f32 v150, v150
    v_rcp_f32 v151, v151
    v_rcp_f32 v152, v152
    v_rcp_f32 v153, v153
    v_rcp_f32 v154, v154
    v_rcp_f32 v155, v155
    v_rcp_f32 v156, v156
    v_rcp_f32 v157, v157
    v_rcp_f32 v158, v158
    v_rcp_f32 v159, v159
    v_pk_mul_f32 v[144:145], v[144:145], v[112:113]
    v_pk_mul_f32 v[146:147], v[146:147], v[114:115]
    v_pk_mul_f32 v[148:149], v[148:149], v[116:117]
    v_pk_mul_f32 v[150:151], v[150:151], v[118:119]
    v_pk_mul_f32 v[152:153], v[152:153], v[120:121]
    v_pk_mul_f32 v[154:155], v[154:155], v[122:123]
    v_pk_mul_f32 v[156:157], v[156:157], v[124:125]
    v_pk_mul_f32 v[158:159], v[158:159], v[126:127]
    v_cvt_pk_bf16_f32 v184, v144, v145
    v_cvt_pk_bf16_f32 v185, v146, v147
    v_cvt_pk_bf16_f32 v186, v148, v149
    v_cvt_pk_bf16_f32 v187, v150, v151
    v_cvt_pk_bf16_f32 v188, v152, v153
    v_cvt_pk_bf16_f32 v189, v154, v155
    v_cvt_pk_bf16_f32 v190, v156, v157
    v_cvt_pk_bf16_f32 v191, v158, v159
    buffer_store_dwordx4 v[184:187], v3, s[44:47], s70 offen sc1
    buffer_store_dwordx4 v[188:191], v3, s[44:47], s70 offen offset:1024 sc1
    s_waitcnt vmcnt(2)
    s_mul_i32 s91, s39, 32768
    s_add_u32 s91, s91, 0
    v_add_u32 v30, s91, v17
    v_add_u32 v31, s91, v18
    ds_read_b64_tr_b16 a[60:61], v30 offset:0
    ds_read_b64_tr_b16 a[62:63], v30 offset:1024
    ds_read_b64_tr_b16 a[172:173], v31 offset:0
    ds_read_b64_tr_b16 a[174:175], v31 offset:1024
    ds_read_b64_tr_b16 a[64:65], v30 offset:2048
    ds_read_b64_tr_b16 a[66:67], v30 offset:3072
    ds_read_b64_tr_b16 a[176:177], v31 offset:2048
    ds_read_b64_tr_b16 a[178:179], v31 offset:3072
    ds_read_b64_tr_b16 a[68:69], v30 offset:4096
    ds_read_b64_tr_b16 a[70:71], v30 offset:5120
    ds_read_b64_tr_b16 a[180:181], v31 offset:4096
    ds_read_b64_tr_b16 a[182:183], v31 offset:5120
    ds_read_b64_tr_b16 a[72:73], v30 offset:6144
    ds_read_b64_tr_b16 a[74:75], v30 offset:7168
    ds_read_b64_tr_b16 a[184:185], v31 offset:6144
    ds_read_b64_tr_b16 a[186:187], v31 offset:7168
    ds_read_b64_tr_b16 a[76:77], v30 offset:8192
    ds_read_b64_tr_b16 a[78:79], v30 offset:9216
    ds_read_b64_tr_b16 a[188:189], v31 offset:8192
    ds_read_b64_tr_b16 a[190:191], v31 offset:9216
    ds_read_b64_tr_b16 a[80:81], v30 offset:10240
    ds_read_b64_tr_b16 a[82:83], v30 offset:11264
    ds_read_b64_tr_b16 a[192:193], v31 offset:10240
    ds_read_b64_tr_b16 a[194:195], v31 offset:11264
    s_waitcnt vmcnt(0)
    s_barrier
    s_mul_i32 s62, s60, 14
    s_add_u32 s62, s62, s61
    s_cmp_lg_u32 s39, 0
    s_cbranch_scc1 L_fl_14
    s_lshl_b32 s67, s62, 7
    s_add_u32 s67, s67, 196608
    v_mov_b32 v5, 0
    v_mov_b32 v6, s38
    s_mov_b64 s[72:73], exec
    s_mov_b64 exec, 1
    buffer_store_dword v6, v5, s[44:47], s67 offen sc1
    s_mov_b64 exec, s[72:73]
L_fl_14:
    s_mov_b32 m0, s89
    s_add_u32 s89, s89, 2048
    buffer_load_dwordx4 v16, s[52:55], s90 offen lds
    buffer_load_dwordx4 v19, s[52:55], s90 offen offset:1024 lds
    s_add_u32 s90, s90, 16384
    s_cmp_ge_u32 s90, 458752
    s_cselect_b32 s91, 458752, 0
    s_sub_u32 s90, s90, s91
    s_mov_b32 m0, s89
    s_add_u32 s89, s89, 2048
    buffer_load_dwordx4 v16, s[52:55], s90 offen lds
    buffer_load_dwordx4 v19, s[52:55], s90 offen offset:1024 lds
    s_add_u32 s90, s90, 16384
    s_cmp_ge_u32 s90, 458752
    s_cselect_b32 s91, 458752, 0
    s_sub_u32 s90, s90, s91
    s_mov_b32 m0, s89
    s_add_u32 s89, s89, 2048
    buffer_load_dwordx4 v16, s[52:55], s90 offen lds
    buffer_load_dwordx4 v19, s[52:55], s90 offen offset:1024 lds
    s_add_u32 s90, s90, 16384
    s_cmp_ge_u32 s90, 458752
    s_cselect_b32 s91, 458752, 0
    s_sub_u32 s90, s90, s91
    s_mov_b32 m0, s89
    s_add_u32 s89, s89, 2048
    buffer_load_dwordx4 v16, s[52:55], s90 offen lds
    buffer_load_dwordx4 v19, s[52:55], s90 offen offset:1024 lds
    s_add_u32 s90, s90, 16384
    s_cmp_ge_u32 s90, 458752
    s_cselect_b32 s91, 458752, 0
    s_sub_u32 s90, s90, s91
    s_mov_b32 m0, s89
    s_add_u32 s89, s89, 2048
    buffer_load_dwordx4 v16, s[52:55], s90 offen lds
    buffer_load_dwordx4 v19, s[52:55], s90 offen offset:1024 lds
    s_add_u32 s90, s90, 16384
    s_cmp_ge_u32 s90, 458752
    s_cselect_b32 s91, 458752, 0
    s_sub_u32 s90, s90, s91
    s_mov_b32 m0, s89
    s_add_u32 s89, s89, 2048
    buffer_load_dwordx4 v16, s[52:55], s90 offen lds
    buffer_load_dwordx4 v19, s[52:55], s90 offen offset:1024 lds
    s_add_u32 s90, s90, 16384
    s_cmp_ge_u32 s90, 458752
    s_cselect_b32 s91, 458752, 0
    s_sub_u32 s90, s90, s91
    s_mov_b32 m0, s89
    s_add_u32 s89, s89, 2048
    buffer_load_dwordx4 v16, s[52:55], s90 offen lds
    buffer_load_dwordx4 v19, s[52:55], s90 offen offset:1024 lds
    s_add_u32 s90, s90, 16384
    s_cmp_ge_u32 s90, 458752
    s_cselect_b32 s91, 458752, 0
    s_sub_u32 s90, s90, s91
    s_waitcnt vmcnt(0)
    s_mul_i32 s91, s39, 32768
    s_add_u32 s91, s91, 0
    v_add_u32 v30, s91, v17
    v_add_u32 v31, s91, v18
    ds_read_b64_tr_b16 a[84:85], v30 offset:12288
    ds_read_b64_tr_b16 a[86:87], v30 offset:13312
    ds_read_b64_tr_b16 a[196:197], v31 offset:12288
    ds_read_b64_tr_b16 a[198:199], v31 offset:13312
    ds_read_b64_tr_b16 a[88:89], v30 offset:14336
    ds_read_b64_tr_b16 a[90:91], v30 offset:15360
    ds_read_b64_tr_b16 a[200:201], v31 offset:14336
    ds_read_b64_tr_b16 a[202:203], v31 offset:15360
    ds_read_b64_tr_b16 a[92:93], v30 offset:16384
    ds_read_b64_tr_b16 a[94:95], v30 offset:17408
    ds_read_b64_tr_b16 a[204:205], v31 offset:16384
    ds_read_b64_tr_b16 a[206:207], v31 offset:17408
    ds_read_b64_tr_b16 a[96:97], v30 offset:18432
    ds_read_b64_tr_b16 a[98:99], v30 offset:19456
    ds_read_b64_tr_b16 a[208:209], v31 offset:18432
    ds_read_b64_tr_b16 a[210:211], v31 offset:19456
    ds_read_b64_tr_b16 a[100:101], v30 offset:20480
    ds_read_b64_tr_b16 a[102:103], v30 offset:21504
    ds_read_b64_tr_b16 a[212:213], v31 offset:20480
    ds_read_b64_tr_b16 a[214:215], v31 offset:21504
    ds_read_b64_tr_b16 a[104:105], v30 offset:22528
    ds_read_b64_tr_b16 a[106:107], v30 offset:23552
    ds_read_b64_tr_b16 a[216:217], v31 offset:22528
    ds_read_b64_tr_b16 a[218:219], v31 offset:23552
    ds_read_b64_tr_b16 a[108:109], v30 offset:24576
    ds_read_b64_tr_b16 a[110:111], v30 offset:25600
    ds_read_b64_tr_b16 a[220:221], v31 offset:24576
    ds_read_b64_tr_b16 a[222:223], v31 offset:25600
    s_waitcnt lgkmcnt(0)
    s_barrier
    s_branch L_skipD2
L_skipD:
    s_mul_i32 s91, s39, 22528
    s_add_u32 s91, s91, 69632
    v_add_u32 v30, s91, v17
    v_add_u32 v31, s91, v18
    ds_read_b64_tr_b16 a[16:17], v30 offset:0
    ds_read_b64_tr_b16 a[18:19], v30 offset:1024
    ds_read_b64_tr_b16 a[128:129], v31 offset:0
    ds_read_b64_tr_b16 a[130:131], v31 offset:1024
    ds_read_b64_tr_b16 a[20:21], v30 offset:2048
    ds_read_b64_tr_b16 a[22:23], v30 offset:3072
    ds_read_b64_tr_b16 a[132:133], v31 offset:2048
    ds_read_b64_tr_b16 a[134:135], v31 offset:3072
    ds_read_b64_tr_b16 a[24:25], v30 offset:4096
    ds_read_b64_tr_b16 a[26:27], v30 offset:5120
    ds_read_b64_tr_b16 a[136:137], v31 offset:4096
    ds_read_b64_tr_b16 a[138:139], v31 offset:5120
    ds_read_b64_tr_b16 a[28:29], v30 offset:6144
    ds_read_b64_tr_b16 a[30:31], v30 offset:7168
    ds_read_b64_tr_b16 a[140:141], v31 offset:6144
    ds_read_b64_tr_b16 a[142:143], v31 offset:7168
    ds_read_b64_tr_b16 a[32:33], v30 offset:8192
    ds_read_b64_tr_b16 a[34:35], v30 offset:9216
    ds_read_b64_tr_b16 a[144:145], v31 offset:8192
    ds_read_b64_tr_b16 a[146:147], v31 offset:9216
    ds_read_b64_tr_b16 a[36:37], v30 offset:10240
    ds_read_b64_tr_b16 a[38:39], v30 offset:11264
    ds_read_b64_tr_b16 a[148:149], v31 offset:10240
    ds_read_b64_tr_b16 a[150:151], v31 offset:11264
    ds_read_b64_tr_b16 a[40:41], v30 offset:12288
    ds_read_b64_tr_b16 a[42:43], v30 offset:13312
    ds_read_b64_tr_b16 a[152:153], v31 offset:12288
    ds_read_b64_tr_b16 a[154:155], v31 offset:13312
    ds_read_b64_tr_b16 a[44:45], v30 offset:14336
    ds_read_b64_tr_b16 a[46:47], v30 offset:15360
    ds_read_b64_tr_b16 a[156:157], v31 offset:14336
    ds_read_b64_tr_b16 a[158:159], v31 offset:15360
    ds_read_b64_tr_b16 a[48:49], v30 offset:16384
    ds_read_b64_tr_b16 a[50:51], v30 offset:17408
    ds_read_b64_tr_b16 a[160:161], v31 offset:16384
    ds_read_b64_tr_b16 a[162:163], v31 offset:17408
    ds_read_b64_tr_b16 a[52:53], v30 offset:18432
    ds_read_b64_tr_b16 a[54:55], v30 offset:19456
    ds_read_b64_tr_b16 a[164:165], v31 offset:18432
    ds_read_b64_tr_b16 a[166:167], v31 offset:19456
    ds_read_b64_tr_b16 a[56:57], v30 offset:20480
    ds_read_b64_tr_b16 a[58:59], v30 offset:21504
    ds_read_b64_tr_b16 a[168:169], v31 offset:20480
    ds_read_b64_tr_b16 a[170:171], v31 offset:21504
    s_waitcnt lgkmcnt(0)
    s_sub_u32 s60, s41, 28
    s_lshl_b32 s61, s40, 2
    s_add_u32 s61, s61, s60
    s_mul_i32 s62, s61, 112
    v_lshrrev_b32 v2, 3, v0
    v_mul_u32_u24 v2, 57344, v2
    v_and_b32 v3, 7, v0
    v_lshlrev_b32 v3, 4, v3
    v_add3_u32 v2, v2, v3, s62
    s_mov_b32 s63, 0
    buffer_load_dwordx4 v[64:67], v2, s[56:59], s63 offen
    s_add_u32 s63, s63, 3584
    buffer_load_dwordx4 v[68:71], v2, s[56:59], s63 offen
    s_add_u32 s63, s63, 3584
    buffer_load_dwordx4 v[72:75], v2, s[56:59], s63 offen
    s_add_u32 s63, s63, 3584
    buffer_load_dwordx4 v[76:79], v2, s[56:59], s63 offen
    s_add_u32 s63, s63, 3584
    buffer_load_dwordx4 v[80:83], v2, s[56:59], s63 offen
    s_add_u32 s63, s63, 3584
    buffer_load_dwordx4 v[84:87], v2, s[56:59], s63 offen
    s_add_u32 s63, s63, 3584
    buffer_load_dwordx4 v[88:91], v2, s[56:59], s63 offen
    s_add_u32 s63, s63, 3584
    buffer_load_dwordx4 v[92:95], v2, s[56:59], s63 offen
    s_add_u32 s63, s63, 3584
    buffer_load_dwordx4 v[96:99], v2, s[56:59], s63 offen
    s_add_u32 s63, s63, 3584
    buffer_load_dwordx4 v[100:103], v2, s[56:59], s63 offen
    s_add_u32 s63, s63, 3584
    buffer_load_dwordx4 v[104:107], v2, s[56:59], s63 offen
    s_add_u32 s63, s63, 3584
    buffer_load_dwordx4 v[108:111], v2, s[56:59], s63 offen
    s_add_u32 s63, s63, 3584
    buffer_load_dwordx4 v[112:115], v2, s[56:59], s63 offen
    s_add_u32 s63, s63, 3584
    buffer_load_dwordx4 v[116:119], v2, s[56:59], s63 offen
    s_add_u32 s63, s63, 3584
    buffer_load_dwordx4 v[120:123], v2, s[56:59], s63 offen
    s_add_u32 s63, s63, 3584
    buffer_load_dwordx4 v[124:127], v2, s[56:59], s63 offen
    v_mov_b32 v128, 0
    v_mov_b32 v129, 0
    v_mov_b32 v130, 0
    v_mov_b32 v131, 0
    v_mov_b32 v132, 0
    v_mov_b32 v133, 0
    v_mov_b32 v134, 0
    v_mov_b32 v135, 0
    s_waitcnt vmcnt(15)
    v_lshlrev_b32 v136, 16, v64
    v_and_b32 v137, 0xffff0000, v64
    v_lshlrev_b32 v138, 16, v65
    v_and_b32 v139, 0xffff0000, v65
    v_lshlrev_b32 v140, 16, v66
    v_and_b32 v141, 0xffff0000, v66
    v_lshlrev_b32 v142, 16, v67
    v_and_b32 v143, 0xffff0000, v67
    v_pk_add_f32 v[128:129], v[128:129], v[136:137]
    v_pk_add_f32 v[130:131], v[130:131], v[138:139]
    v_pk_add_f32 v[132:133], v[132:133], v[140:141]
    v_pk_add_f32 v[134:135], v[134:135], v[142:143]
    s_waitcnt vmcnt(14)
    v_lshlrev_b32 v136, 16, v68
    v_and_b32 v137, 0xffff0000, v68
    v_lshlrev_b32 v138, 16, v69
    v_and_b32 v139, 0xffff0000, v69
    v_lshlrev_b32 v140, 16, v70
    v_and_b32 v141, 0xffff0000, v70
    v_lshlrev_b32 v142, 16, v71
    v_and_b32 v143, 0xffff0000, v71
    v_pk_add_f32 v[128:129], v[128:129], v[136:137]
    v_pk_add_f32 v[130:131], v[130:131], v[138:139]
    v_pk_add_f32 v[132:133], v[132:133], v[140:141]
    v_pk_add_f32 v[134:135], v[134:135], v[142:143]
    s_waitcnt vmcnt(13)
    v_lshlrev_b32 v136, 16, v72
    v_and_b32 v137, 0xffff0000, v72
    v_lshlrev_b32 v138, 16, v73
    v_and_b32 v139, 0xffff0000, v73
    v_lshlrev_b32 v140, 16, v74
    v_and_b32 v141, 0xffff0000, v74
    v_lshlrev_b32 v142, 16, v75
    v_and_b32 v143, 0xffff0000, v75
    v_pk_add_f32 v[128:129], v[128:129], v[136:137]
    v_pk_add_f32 v[130:131], v[130:131], v[138:139]
    v_pk_add_f32 v[132:133], v[132:133], v[140:141]
    v_pk_add_f32 v[134:135], v[134:135], v[142:143]
    s_waitcnt vmcnt(12)
    v_lshlrev_b32 v136, 16, v76
    v_and_b32 v137, 0xffff0000, v76
    v_lshlrev_b32 v138, 16, v77
    v_and_b32 v139, 0xffff0000, v77
    v_lshlrev_b32 v140, 16, v78
    v_and_b32 v141, 0xffff0000, v78
    v_lshlrev_b32 v142, 16, v79
    v_and_b32 v143, 0xffff0000, v79
    v_pk_add_f32 v[128:129], v[128:129], v[136:137]
    v_pk_add_f32 v[130:131], v[130:131], v[138:139]
    v_pk_add_f32 v[132:133], v[132:133], v[140:141]
    v_pk_add_f32 v[134:135], v[134:135], v[142:143]
    s_waitcnt vmcnt(11)
    v_lshlrev_b32 v136, 16, v80
    v_and_b32 v137, 0xffff0000, v80
    v_lshlrev_b32 v138, 16, v81
    v_and_b32 v139, 0xffff0000, v81
    v_lshlrev_b32 v140, 16, v82
    v_and_b32 v141, 0xffff0000, v82
    v_lshlrev_b32 v142, 16, v83
    v_and_b32 v143, 0xffff0000, v83
    v_pk_add_f32 v[128:129], v[128:129], v[136:137]
    v_pk_add_f32 v[130:131], v[130:131], v[138:139]
    v_pk_add_f32 v[132:133], v[132:133], v[140:141]
    v_pk_add_f32 v[134:135], v[134:135], v[142:143]
    s_waitcnt vmcnt(10)
    v_lshlrev_b32 v136, 16, v84
    v_and_b32 v137, 0xffff0000, v84
    v_lshlrev_b32 v138, 16, v85
    v_and_b32 v139, 0xffff0000, v85
    v_lshlrev_b32 v140, 16, v86
    v_and_b32 v141, 0xffff0000, v86
    v_lshlrev_b32 v142, 16, v87
    v_and_b32 v143, 0xffff0000, v87
    v_pk_add_f32 v[128:129], v[128:129], v[136:137]
    v_pk_add_f32 v[130:131], v[130:131], v[138:139]
    v_pk_add_f32 v[132:133], v[132:133], v[140:141]
    v_pk_add_f32 v[134:135], v[134:135], v[142:143]
    s_waitcnt vmcnt(9)
    v_lshlrev_b32 v136, 16, v88
    v_and_b32 v137, 0xffff0000, v88
    v_lshlrev_b32 v138, 16, v89
    v_and_b32 v139, 0xffff0000, v89
    v_lshlrev_b32 v140, 16, v90
    v_and_b32 v141, 0xffff0000, v90
    v_lshlrev_b32 v142, 16, v91
    v_and_b32 v143, 0xffff0000, v91
    v_pk_add_f32 v[128:129], v[128:129], v[136:137]
    v_pk_add_f32 v[130:131], v[130:131], v[138:139]
    v_pk_add_f32 v[132:133], v[132:133], v[140:141]
    v_pk_add_f32 v[134:135], v[134:135], v[142:143]
    s_waitcnt vmcnt(8)
    v_lshlrev_b32 v136, 16, v92
    v_and_b32 v137, 0xffff0000, v92
    v_lshlrev_b32 v138, 16, v93
    v_and_b32 v139, 0xffff0000, v93
    v_lshlrev_b32 v140, 16, v94
    v_and_b32 v141, 0xffff0000, v94
    v_lshlrev_b32 v142, 16, v95
    v_and_b32 v143, 0xffff0000, v95
    v_pk_add_f32 v[128:129], v[128:129], v[136:137]
    v_pk_add_f32 v[130:131], v[130:131], v[138:139]
    v_pk_add_f32 v[132:133], v[132:133], v[140:141]
    v_pk_add_f32 v[134:135], v[134:135], v[142:143]
    s_waitcnt vmcnt(7)
    v_lshlrev_b32 v136, 16, v96
    v_and_b32 v137, 0xffff0000, v96
    v_lshlrev_b32 v138, 16, v97
    v_and_b32 v139, 0xffff0000, v97
    v_lshlrev_b32 v140, 16, v98
    v_and_b32 v141, 0xffff0000, v98
    v_lshlrev_b32 v142, 16, v99
    v_and_b32 v143, 0xffff0000, v99
    v_pk_add_f32 v[128:129], v[128:129], v[136:137]
    v_pk_add_f32 v[130:131], v[130:131], v[138:139]
    v_pk_add_f32 v[132:133], v[132:133], v[140:141]
    v_pk_add_f32 v[134:135], v[134:135], v[142:143]
    s_waitcnt vmcnt(6)
    v_lshlrev_b32 v136, 16, v100
    v_and_b32 v137, 0xffff0000, v100
    v_lshlrev_b32 v138, 16, v101
    v_and_b32 v139, 0xffff0000, v101
    v_lshlrev_b32 v140, 16, v102
    v_and_b32 v141, 0xffff0000, v102
    v_lshlrev_b32 v142, 16, v103
    v_and_b32 v143, 0xffff0000, v103
    v_pk_add_f32 v[128:129], v[128:129], v[136:137]
    v_pk_add_f32 v[130:131], v[130:131], v[138:139]
    v_pk_add_f32 v[132:133], v[132:133], v[140:141]
    v_pk_add_f32 v[134:135], v[134:135], v[142:143]
    s_waitcnt vmcnt(5)
    v_lshlrev_b32 v136, 16, v104
    v_and_b32 v137, 0xffff0000, v104
    v_lshlrev_b32 v138, 16, v105
    v_and_b32 v139, 0xffff0000, v105
    v_lshlrev_b32 v140, 16, v106
    v_and_b32 v141, 0xffff0000, v106
    v_lshlrev_b32 v142, 16, v107
    v_and_b32 v143, 0xffff0000, v107
    v_pk_add_f32 v[128:129], v[128:129], v[136:137]
    v_pk_add_f32 v[130:131], v[130:131], v[138:139]
    v_pk_add_f32 v[132:133], v[132:133], v[140:141]
    v_pk_add_f32 v[134:135], v[134:135], v[142:143]
    s_waitcnt vmcnt(4)
    v_lshlrev_b32 v136, 16, v108
    v_and_b32 v137, 0xffff0000, v108
    v_lshlrev_b32 v138, 16, v109
    v_and_b32 v139, 0xffff0000, v109
    v_lshlrev_b32 v140, 16, v110
    v_and_b32 v141, 0xffff0000, v110
    v_lshlrev_b32 v142, 16, v111
    v_and_b32 v143, 0xffff0000, v111
    v_pk_add_f32 v[128:129], v[128:129], v[136:137]
    v_pk_add_f32 v[130:131], v[130:131], v[138:139]
    v_pk_add_f32 v[132:133], v[132:133], v[140:141]
    v_pk_add_f32 v[134:135], v[134:135], v[142:143]
    s_waitcnt vmcnt(3)
    v_lshlrev_b32 v136, 16, v112
    v_and_b32 v137, 0xffff0000, v112
    v_lshlrev_b32 v138, 16, v113
    v_and_b32 v139, 0xffff0000, v113
    v_lshlrev_b32 v140, 16, v114
    v_and_b32 v141, 0xffff0000, v114
    v_lshlrev_b32 v142, 16, v115
    v_and_b32 v143, 0xffff0000, v115
    v_pk_add_f32 v[128:129], v[128:129], v[136:137]
    v_pk_add_f32 v[130:131], v[130:131], v[138:139]
    v_pk_add_f32 v[132:133], v[132:133], v[140:141]
    v_pk_add_f32 v[134:135], v[134:135], v[142:143]
    s_waitcnt vmcnt(2)
    v_lshlrev_b32 v136, 16, v116
    v_and_b32 v137, 0xffff0000, v116
    v_lshlrev_b32 v138, 16, v117
    v_and_b32 v139, 0xffff0000, v117
    v_lshlrev_b32 v140, 16, v118
    v_and_b32 v141, 0xffff0000, v118
    v_lshlrev_b32 v142, 16, v119
    v_and_b32 v143, 0xffff0000, v119
    v_pk_add_f32 v[128:129], v[128:129], v[136:137]
    v_pk_add_f32 v[130:131], v[130:131], v[138:139]
    v_pk_add_f32 v[132:133], v[132:133], v[140:141]
    v_pk_add_f32 v[134:135], v[134:135], v[142:143]
    s_waitcnt vmcnt(1)
    v_lshlrev_b32 v136, 16, v120
    v_and_b32 v137, 0xffff0000, v120
    v_lshlrev_b32 v138, 16, v121
    v_and_b32 v139, 0xffff0000, v121
    v_lshlrev_b32 v140, 16, v122
    v_and_b32 v141, 0xffff0000, v122
    v_lshlrev_b32 v142, 16, v123
    v_and_b32 v143, 0xffff0000, v123
    v_pk_add_f32 v[128:129], v[128:129], v[136:137]
    v_pk_add_f32 v[130:131], v[130:131], v[138:139]
    v_pk_add_f32 v[132:133], v[132:133], v[140:141]
    v_pk_add_f32 v[134:135], v[134:135], v[142:143]
    s_waitcnt vmcnt(0)
    v_lshlrev_b32 v136, 16, v124
    v_and_b32 v137, 0xffff0000, v124
    v_lshlrev_b32 v138, 16, v125
    v_and_b32 v139, 0xffff0000, v125
    v_lshlrev_b32 v140, 16, v126
    v_and_b32 v141, 0xffff0000, v126
    v_lshlrev_b32 v142, 16, v127
    v_and_b32 v143, 0xffff0000, v127
    v_pk_add_f32 v[128:129], v[128:129], v[136:137]
    v_pk_add_f32 v[130:131], v[130:131], v[138:139]
    v_pk_add_f32 v[132:133], v[132:133], v[140:141]
    v_pk_add_f32 v[134:135], v[134:135], v[142:143]
    v_lshlrev_b32 v4, 5, v0
    ds_write_b128 v4, v[128:131]
    ds_write_b128 v4, v[132:135] offset:16
    v_lshlrev_b32 v4, 2, v0
    s_waitcnt lgkmcnt(0)
    s_barrier
    ds_read_b32 v64, v4 offset:0
    ds_read_b32 v65, v4 offset:256
    ds_read_b32 v66, v4 offset:512
    ds_read_b32 v67, v4 offset:768
    ds_read_b32 v68, v4 offset:1024
    ds_read_b32 v69, v4 offset:1280
    ds_read_b32 v70, v4 offset:1536
    ds_read_b32 v71, v4 offset:1792
    ds_read_b32 v72, v4 offset:2048
    ds_read_b32 v73, v4 offset:2304
    ds_read_b32 v74, v4 offset:2560
    ds_read_b32 v75, v4 offset:2816
    ds_read_b32 v76, v4 offset:3072
    ds_read_b32 v77, v4 offset:3328
    ds_read_b32 v78, v4 offset:3584
    ds_read_b32 v79, v4 offset:3840
    ds_read_b32 v80, v4 offset:4096
    ds_read_b32 v81, v4 offset:4352
    ds_read_b32 v82, v4 offset:4608
    ds_read_b32 v83, v4 offset:4864
    ds_read_b32 v84, v4 offset:5120
    ds_read_b32 v85, v4 offset:5376
    ds_read_b32 v86, v4 offset:5632
    ds_read_b32 v87, v4 offset:5888
    ds_read_b32 v88, v4 offset:6144
    ds_read_b32 v89, v4 offset:6400
    ds_read_b32 v90, v4 offset:6656
    ds_read_b32 v91, v4 offset:6912
    ds_read_b32 v92, v4 offset:7168
    ds_read_b32 v93, v4 offset:7424
    ds_read_b32 v94, v4 offset:7680
    ds_read_b32 v95, v4 offset:7936
    s_waitcnt lgkmcnt(0)
    v_add_f32 v64, v64, v80
    v_add_f32 v65, v65, v81
    v_add_f32 v66, v66, v82
    v_add_f32 v67, v67, v83
    v_add_f32 v68, v68, v84
    v_add_f32 v69, v69, v85
    v_add_f32 v70, v70, v86
    v_add_f32 v71, v71, v87
    v_add_f32 v72, v72, v88
    v_add_f32 v73, v73, v89
    v_add_f32 v74, v74, v90
    v_add_f32 v75, v75, v91
    v_add_f32 v76, v76, v92
    v_add_f32 v77, v77, v93
    v_add_f32 v78, v78, v94
    v_add_f32 v79, v79, v95
    v_add_f32 v64, v64, v72
    v_add_f32 v65, v65, v73
    v_add_f32 v66, v66, v74
    v_add_f32 v67, v67, v75
    v_add_f32 v68, v68, v76
    v_add_f32 v69, v69, v77
    v_add_f32 v70, v70, v78
    v_add_f32 v71, v71, v79
    v_add_f32 v64, v64, v68
    v_add_f32 v65, v65, v69
    v_add_f32 v66, v66, v70
    v_add_f32 v67, v67, v71
    v_add_f32 v64, v64, v66
    v_add_f32 v65, v65, v67
    v_add_f32 v64, v64, v65
    s_mul_i32 s62, s61, 448
    s_add_u32 s62, s62, 262144
    v_lshlrev_b32 v4, 3, v0
    v_mov_b32 v65, s38
    v_cmp_gt_u32 vcc, 56, v0
    s_nop 0
    s_and_saveexec_b64 s[72:73], vcc
    buffer_store_dwordx2 v[64:65], v4, s[44:47], s62 offen sc1
    s_mov_b64 exec, s[72:73]
    v_lshlrev_b32 v5, 7, v0
    v_add_u32 v5, 131072, v5
    s_mov_b32 s83, 0
L_pollcf_15:
    buffer_load_dword v6, v5, s[44:47], 0 offen sc1
    s_waitcnt vmcnt(0)
    v_cmp_ne_u32 vcc, s38, v6
    s_add_u32 s83, s83, 1
    s_cmp_ge_u32 s83, 65536
    s_cbranch_scc1 L_pollcf_done_16
    s_cbranch_vccnz L_pollcf_15
L_pollcf_done_16:
    s_barrier
    s_lshl_b32 s62, s40, 1
    s_lshr_b32 s63, s60, 1
    s_add_u32 s62, s62, s63
    s_lshl_b32 s62, s62, 17
    s_and_b32 s63, s60, 1
    s_lshl_b32 s63, s63, 8
    s_add_u32 s62, s62, s63
    s_add_u32 s62, s62, 1048576
    v_lshrrev_b32 v2, 4, v0
    v_lshlrev_b32 v2, 13, v2
    v_and_b32 v3, 15, v0
    v_lshlrev_b32 v3, 4, v3
    v_add_u32 v2, v2, v3
    s_add_u32 s63, s62, 4096
    buffer_load_dwordx4 v[64:67], v2, s[44:47], s62 offen offset:0 sc1
    buffer_load_dwordx4 v[68:71], v2, s[44:47], s62 offen offset:512 sc1
    buffer_load_dwordx4 v[72:75], v2, s[44:47], s62 offen offset:1024 sc1
    buffer_load_dwordx4 v[76:79], v2, s[44:47], s62 offen offset:1536 sc1
    buffer_load_dwordx4 v[80:83], v2, s[44:47], s62 offen offset:2048 sc1
    buffer_load_dwordx4 v[84:87], v2, s[44:47], s62 offen offset:2560 sc1
    buffer_load_dwordx4 v[88:91], v2, s[44:47], s62 offen offset:3072 sc1
    buffer_load_dwordx4 v[92:95], v2, s[44:47], s62 offen offset:3584 sc1
    buffer_load_dwordx4 v[96:99], v2, s[44:47], s63 offen offset:0 sc1
    buffer_load_dwordx4 v[100:103], v2, s[44:47], s63 offen offset:512 sc1
    buffer_load_dwordx4 v[104:107], v2, s[44:47], s63 offen offset:1024 sc1
    buffer_load_dwordx4 v[108:111], v2, s[44:47], s63 offen offset:1536 sc1
    buffer_load_dwordx4 v[112:115], v2, s[44:47], s63 offen offset:2048 sc1
    buffer_load_dwordx4 v[116:119], v2, s[44:47], s63 offen offset:2560 sc1
    buffer_load_dwordx4 v[120:123], v2, s[44:47], s63 offen offset:3072 sc1
    buffer_load_dwordx4 v[124:127], v2, s[44:47], s63 offen offset:3584 sc1
    s_mov_b32 s65, 0x3f803f80
    v_mov_b32 v128, 0
    v_mov_b32 v129, 0
    v_mov_b32 v130, 0
    v_mov_b32 v131, 0
    v_mov_b32 v132, 0
    v_mov_b32 v133, 0
    v_mov_b32 v134, 0
    v_mov_b32 v135, 0
    s_waitcnt vmcnt(15)
    v_dot2_f32_bf16 v128, v64, s65, v128
    v_dot2_f32_bf16 v132, v64, v64, v132
    v_dot2_f32_bf16 v129, v65, s65, v129
    v_dot2_f32_bf16 v133, v65, v65, v133
    v_dot2_f32_bf16 v130, v66, s65, v130
    v_dot2_f32_bf16 v134, v66, v66, v134
    v_dot2_f32_bf16 v131, v67, s65, v131
    v_dot2_f32_bf16 v135, v67, v67, v135
    s_waitcnt vmcnt(14)
    v_dot2_f32_bf16 v128, v68, s65, v128
    v_dot2_f32_bf16 v132, v68, v68, v132
    v_dot2_f32_bf16 v129, v69, s65, v129
    v_dot2_f32_bf16 v133, v69, v69, v133
    v_dot2_f32_bf16 v130, v70, s65, v130
    v_dot2_f32_bf16 v134, v70, v70, v134
    v_dot2_f32_bf16 v131, v71, s65, v131
    v_dot2_f32_bf16 v135, v71, v71, v135
    s_waitcnt vmcnt(13)
    v_dot2_f32_bf16 v128, v72, s65, v128
    v_dot2_f32_bf16 v132, v72, v72, v132
    v_dot2_f32_bf16 v129, v73, s65, v129
    v_dot2_f32_bf16 v133, v73, v73, v133
    v_dot2_f32_bf16 v130, v74, s65, v130
    v_dot2_f32_bf16 v134, v74, v74, v134
    v_dot2_f32_bf16 v131, v75, s65, v131
    v_dot2_f32_bf16 v135, v75, v75, v135
    s_waitcnt vmcnt(12)
    v_dot2_f32_bf16 v128, v76, s65, v128
    v_dot2_f32_bf16 v132, v76, v76, v132
    v_dot2_f32_bf16 v129, v77, s65, v129
    v_dot2_f32_bf16 v133, v77, v77, v133
    v_dot2_f32_bf16 v130, v78, s65, v130
    v_dot2_f32_bf16 v134, v78, v78, v134
    v_dot2_f32_bf16 v131, v79, s65, v131
    v_dot2_f32_bf16 v135, v79, v79, v135
    s_waitcnt vmcnt(11)
    v_dot2_f32_bf16 v128, v80, s65, v128
    v_dot2_f32_bf16 v132, v80, v80, v132
    v_dot2_f32_bf16 v129, v81, s65, v129
    v_dot2_f32_bf16 v133, v81, v81, v133
    v_dot2_f32_bf16 v130, v82, s65, v130
    v_dot2_f32_bf16 v134, v82, v82, v134
    v_dot2_f32_bf16 v131, v83, s65, v131
    v_dot2_f32_bf16 v135, v83, v83, v135
    s_waitcnt vmcnt(10)
    v_dot2_f32_bf16 v128, v84, s65, v128
    v_dot2_f32_bf16 v132, v84, v84, v132
    v_dot2_f32_bf16 v129, v85, s65, v129
    v_dot2_f32_bf16 v133, v85, v85, v133
    v_dot2_f32_bf16 v130, v86, s65, v130
    v_dot2_f32_bf16 v134, v86, v86, v134
    v_dot2_f32_bf16 v131, v87, s65, v131
    v_dot2_f32_bf16 v135, v87, v87, v135
    s_waitcnt vmcnt(9)
    v_dot2_f32_bf16 v128, v88, s65, v128
    v_dot2_f32_bf16 v132, v88, v88, v132
    v_dot2_f32_bf16 v129, v89, s65, v129
    v_dot2_f32_bf16 v133, v89, v89, v133
    v_dot2_f32_bf16 v130, v90, s65, v130
    v_dot2_f32_bf16 v134, v90, v90, v134
    v_dot2_f32_bf16 v131, v91, s65, v131
    v_dot2_f32_bf16 v135, v91, v91, v135
    s_waitcnt vmcnt(8)
    v_dot2_f32_bf16 v128, v92, s65, v128
    v_dot2_f32_bf16 v132, v92, v92, v132
    v_dot2_f32_bf16 v129, v93, s65, v129
    v_dot2_f32_bf16 v133, v93, v93, v133
    v_dot2_f32_bf16 v130, v94, s65, v130
    v_dot2_f32_bf16 v134, v94, v94, v134
    v_dot2_f32_bf16 v131, v95, s65, v131
    v_dot2_f32_bf16 v135, v95, v95, v135
    s_waitcnt vmcnt(7)
    v_dot2_f32_bf16 v128, v96, s65, v128
    v_dot2_f32_bf16 v132, v96, v96, v132
    v_dot2_f32_bf16 v129, v97, s65, v129
    v_dot2_f32_bf16 v133, v97, v97, v133
    v_dot2_f32_bf16 v130, v98, s65, v130
    v_dot2_f32_bf16 v134, v98, v98, v134
    v_dot2_f32_bf16 v131, v99, s65, v131
    v_dot2_f32_bf16 v135, v99, v99, v135
    s_waitcnt vmcnt(6)
    v_dot2_f32_bf16 v128, v100, s65, v128
    v_dot2_f32_bf16 v132, v100, v100, v132
    v_dot2_f32_bf16 v129, v101, s65, v129
    v_dot2_f32_bf16 v133, v101, v101, v133
    v_dot2_f32_bf16 v130, v102, s65, v130
    v_dot2_f32_bf16 v134, v102, v102, v134
    v_dot2_f32_bf16 v131, v103, s65, v131
    v_dot2_f32_bf16 v135, v103, v103, v135
    s_waitcnt vmcnt(5)
    v_dot2_f32_bf16 v128, v104, s65, v128
    v_dot2_f32_bf16 v132, v104, v104, v132
    v_dot2_f32_bf16 v129, v105, s65, v129
    v_dot2_f32_bf16 v133, v105, v105, v133
    v_dot2_f32_bf16 v130, v106, s65, v130
    v_dot2_f32_bf16 v134, v106, v106, v134
    v_dot2_f32_bf16 v131, v107, s65, v131
    v_dot2_f32_bf16 v135, v107, v107, v135
    s_waitcnt vmcnt(4)
    v_dot2_f32_bf16 v128, v108, s65, v128
    v_dot2_f32_bf16 v132, v108, v108, v132
    v_dot2_f32_bf16 v129, v109, s65, v129
    v_dot2_f32_bf16 v133, v109, v109, v133
    v_dot2_f32_bf16 v130, v110, s65, v130
    v_dot2_f32_bf16 v134, v110, v110, v134
    v_dot2_f32_bf16 v131, v111, s65, v131
    v_dot2_f32_bf16 v135, v111, v111, v135
    s_waitcnt vmcnt(3)
    v_dot2_f32_bf16 v128, v112, s65, v128
    v_dot2_f32_bf16 v132, v112, v112, v132
    v_dot2_f32_bf16 v129, v113, s65, v129
    v_dot2_f32_bf16 v133, v113, v113, v133
    v_dot2_f32_bf16 v130, v114, s65, v130
    v_dot2_f32_bf16 v134, v114, v114, v134
    v_dot2_f32_bf16 v131, v115, s65, v131
    v_dot2_f32_bf16 v135, v115, v115, v135
    s_waitcnt vmcnt(2)
    v_dot2_f32_bf16 v128, v116, s65, v128
    v_dot2_f32_bf16 v132, v116, v116, v132
    v_dot2_f32_bf16 v129, v117, s65, v129
    v_dot2_f32_bf16 v133, v117, v117, v133
    v_dot2_f32_bf16 v130, v118, s65, v130
    v_dot2_f32_bf16 v134, v118, v118, v134
    v_dot2_f32_bf16 v131, v119, s65, v131
    v_dot2_f32_bf16 v135, v119, v119, v135
    s_waitcnt vmcnt(1)
    v_dot2_f32_bf16 v128, v120, s65, v128
    v_dot2_f32_bf16 v132, v120, v120, v132
    v_dot2_f32_bf16 v129, v121, s65, v129
    v_dot2_f32_bf16 v133, v121, v121, v133
    v_dot2_f32_bf16 v130, v122, s65, v130
    v_dot2_f32_bf16 v134, v122, v122, v134
    v_dot2_f32_bf16 v131, v123, s65, v131
    v_dot2_f32_bf16 v135, v123, v123, v135
    s_waitcnt vmcnt(0)
    v_dot2_f32_bf16 v128, v124, s65, v128
    v_dot2_f32_bf16 v132, v124, v124, v132
    v_dot2_f32_bf16 v129, v125, s65, v129
    v_dot2_f32_bf16 v133, v125, v125, v133
    v_dot2_f32_bf16 v130, v126, s65, v130
    v_dot2_f32_bf16 v134, v126, v126, v134
    v_dot2_f32_bf16 v131, v127, s65, v131
    v_dot2_f32_bf16 v135, v127, v127, v135
    v_mov_b32 v136, v128
    v_mov_b32 v137, v129
    v_mov_b32 v138, v130
    v_mov_b32 v139, v131
    v_mov_b32 v140, v132
    v_mov_b32 v141, v133
    v_mov_b32 v142, v134
    v_mov_b32 v143, v135
    v_permlane32_swap_b32 v128, v136
    v_permlane32_swap_b32 v129, v137
    v_permlane32_swap_b32 v130, v138
    v_permlane32_swap_b32 v131, v139
    v_permlane32_swap_b32 v132, v140
    v_permlane32_swap_b32 v133, v141
    v_permlane32_swap_b32 v134, v142
    v_permlane32_swap_b32 v135, v143
    v_add_f32 v128, v128, v136
    v_add_f32 v129, v129, v137
    v_add_f32 v130, v130, v138
    v_add_f32 v131, v131, v139
    v_add_f32 v132, v132, v140
    v_add_f32 v133, v133, v141
    v_add_f32 v134, v134, v142
    v_add_f32 v135, v135, v143
    v_mov_b32 v136, v128
    v_mov_b32 v137, v129
    v_mov_b32 v138, v130
    v_mov_b32 v139, v131
    v_mov_b32 v140, v132
    v_mov_b32 v141, v133
    v_mov_b32 v142, v134
    v_mov_b32 v143, v135
    v_permlane16_swap_b32 v128, v136
    v_permlane16_swap_b32 v129, v137
    v_permlane16_swap_b32 v130, v138
    v_permlane16_swap_b32 v131, v139
    v_permlane16_swap_b32 v132, v140
    v_permlane16_swap_b32 v133, v141
    v_permlane16_swap_b32 v134, v142
    v_permlane16_swap_b32 v135, v143
    v_add_f32 v128, v128, v136
    v_add_f32 v129, v129, v137
    v_add_f32 v130, v130, v138
    v_add_f32 v131, v131, v139
    v_add_f32 v132, v132, v140
    v_add_f32 v133, v133, v141
    v_add_f32 v134, v134, v142
    v_add_f32 v135, v135, v143
    s_lshl_b32 s63, s39, 9
    v_and_b32 v4, 15, v1
    v_lshlrev_b32 v4, 2, v4
    v_add_u32 v4, s63, v4
    v_add_u32 v4, 16384, v4
    s_mov_b64 s[72:73], exec
    s_mov_b64 exec, 0xffff
    ds_write_b32 v4, v128 offset:0
    ds_write_b32 v4, v129 offset:64
    ds_write_b32 v4, v130 offset:128
    ds_write_b32 v4, v131 offset:192
    ds_write_b32 v4, v132 offset:256
    ds_write_b32 v4, v133 offset:320
    ds_write_b32 v4, v134 offset:384
    ds_write_b32 v4, v135 offset:448
    s_mov_b64 exec, s[72:73]
    v_and_b32 v4, 3, v0
    v_lshlrev_b32 v4, 6, v4
    v_lshrrev_b32 v5, 2, v0
    v_and_b32 v5, 15, v5
    v_lshlrev_b32 v5, 2, v5
    v_add_u32 v4, v4, v5
    v_add_u32 v4, 16384, v4
    s_waitcnt lgkmcnt(0)
    s_barrier
    ds_read_b32 v64, v4 offset:0
    ds_read_b32 v68, v4 offset:256
    ds_read_b32 v65, v4 offset:512
    ds_read_b32 v69, v4 offset:768
    ds_read_b32 v66, v4 offset:1024
    ds_read_b32 v70, v4 offset:1280
    ds_read_b32 v67, v4 offset:1536
    ds_read_b32 v71, v4 offset:1792
    s_waitcnt lgkmcnt(0)
    v_add_f32 v64, v64, v65
    v_add_f32 v66, v66, v67
    v_add_f32 v68, v68, v69
    v_add_f32 v70, v70, v71
    v_add_f32 v64, v64, v66
    v_add_f32 v68, v68, v70
    v_mul_f32 v20, 0x3b000000, v64
    v_mul_f32 v22, 0x3b000000, v68
    v_fma_f32 v22, -v20, v20, v22
    v_max_f32 v22, 0, v22
    v_cvt_pk_bf16_f32 v21, v20, v22
    v_lshlrev_b32 v23, 16, v21
    v_and_b32 v21, 0xffff0000, v21
    v_add_f32 v21, 0x3727c5ac, v21
    v_cvt_pk_bf16_f32 v21, v21, v21
    v_lshlrev_b32 v21, 16, v21
    v_sqrt_f32 v21, v21
    s_nop 0
    v_cvt_pk_bf16_f32 v21, v21, v21
    v_lshlrev_b32 v21, 16, v21
    v_rcp_f32 v24, v21
    v_sub_f32 v25, v20, v23
    v_mul_f32 v25, v25, v24
    v_mul_f32 v22, v22, v24
    v_mul_f32 v22, v22, v24
    v_cvt_pk_bf16_f32 v25, v25, v22
    v_lshlrev_b32 v26, 16, v25
    v_and_b32 v25, 0xffff0000, v25
    v_add_f32 v25, 0x3727c5ac, v25
    v_cvt_pk_bf16_f32 v25, v25, v25
    v_lshlrev_b32 v25, 16, v25
    v_sqrt_f32 v25, v25
    s_nop 0
    v_cvt_pk_bf16_f32 v25, v25, v25
    v_lshlrev_b32 v25, 16, v25
    v_fma_f32 v27, v26, v21, v23
    v_mul_f32 v26, v21, v25
    v_mov_b32 v64, v26
    v_mov_b32 v65, s38
    v_mov_b32 v66, v27
    v_mov_b32 v67, s38
    s_lshl_b32 s62, s40, 8
    s_lshl_b32 s63, s60, 6
    s_add_u32 s62, s62, s63
    s_lshl_b32 s62, s62, 4
    s_add_u32 s62, s62, 327680
    v_lshlrev_b32 v4, 4, v0
    v_cmp_gt_u32 vcc, 64, v0
    s_nop 0
    s_and_saveexec_b64 s[72:73], vcc
    buffer_store_dwordx4 v[64:67], v4, s[44:47], s62 offen sc1
    s_mov_b64 exec, s[72:73]
    s_barrier
    s_mul_i32 s89, s39, 32768
    s_add_u32 s89, s89, 0
    s_mov_b32 m0, s89
    s_add_u32 s89, s89, 2048
    buffer_load_dwordx4 v16, s[52:55], s90 offen lds
    buffer_load_dwordx4 v19, s[52:55], s90 offen offset:1024 lds
    s_add_u32 s90, s90, 16384
    s_cmp_ge_u32 s90, 458752
    s_cselect_b32 s91, 458752, 0
    s_sub_u32 s90, s90, s91
    s_mov_b32 m0, s89
    s_add_u32 s89, s89, 2048
    buffer_load_dwordx4 v16, s[52:55], s90 offen lds
    buffer_load_dwordx4 v19, s[52:55], s90 offen offset:1024 lds
    s_add_u32 s90, s90, 16384
    s_cmp_ge_u32 s90, 458752
    s_cselect_b32 s91, 458752, 0
    s_sub_u32 s90, s90, s91
    s_mov_b32 m0, s89
    s_add_u32 s89, s89, 2048
    buffer_load_dwordx4 v16, s[52:55], s90 offen lds
    buffer_load_dwordx4 v19, s[52:55], s90 offen offset:1024 lds
    s_add_u32 s90, s90, 16384
    s_cmp_ge_u32 s90, 458752
    s_cselect_b32 s91, 458752, 0
    s_sub_u32 s90, s90, s91
    s_mov_b32 m0, s89
    s_add_u32 s89, s89, 2048
    buffer_load_dwordx4 v16, s[52:55], s90 offen lds
    buffer_load_dwordx4 v19, s[52:55], s90 offen offset:1024 lds
    s_add_u32 s90, s90, 16384
    s_cmp_ge_u32 s90, 458752
    s_cselect_b32 s91, 458752, 0
    s_sub_u32 s90, s90, s91
    s_mov_b32 m0, s89
    s_add_u32 s89, s89, 2048
    buffer_load_dwordx4 v16, s[52:55], s90 offen lds
    buffer_load_dwordx4 v19, s[52:55], s90 offen offset:1024 lds
    s_add_u32 s90, s90, 16384
    s_cmp_ge_u32 s90, 458752
    s_cselect_b32 s91, 458752, 0
    s_sub_u32 s90, s90, s91
    s_mov_b32 m0, s89
    s_add_u32 s89, s89, 2048
    buffer_load_dwordx4 v16, s[52:55], s90 offen lds
    buffer_load_dwordx4 v19, s[52:55], s90 offen offset:1024 lds
    s_add_u32 s90, s90, 16384
    s_cmp_ge_u32 s90, 458752
    s_cselect_b32 s91, 458752, 0
    s_sub_u32 s90, s90, s91
    s_mov_b32 m0, s89
    s_add_u32 s89, s89, 2048
    buffer_load_dwordx4 v16, s[52:55], s90 offen lds
    buffer_load_dwordx4 v19, s[52:55], s90 offen offset:1024 lds
    s_add_u32 s90, s90, 16384
    s_cmp_ge_u32 s90, 458752
    s_cselect_b32 s91, 458752, 0
    s_sub_u32 s90, s90, s91
    s_mov_b32 m0, s89
    s_add_u32 s89, s89, 2048
    buffer_load_dwordx4 v16, s[52:55], s90 offen lds
    buffer_load_dwordx4 v19, s[52:55], s90 offen offset:1024 lds
    s_add_u32 s90, s90, 16384
    s_cmp_ge_u32 s90, 458752
    s_cselect_b32 s91, 458752, 0
    s_sub_u32 s90, s90, s91
    s_mov_b32 m0, s89
    s_add_u32 s89, s89, 2048
    buffer_load_dwordx4 v16, s[52:55], s90 offen lds
    buffer_load_dwordx4 v19, s[52:55], s90 offen offset:1024 lds
    s_add_u32 s90, s90, 16384
    s_cmp_ge_u32 s90, 458752
    s_cselect_b32 s91, 458752, 0
    s_sub_u32 s90, s90, s91
    s_mov_b32 m0, s89
    s_add_u32 s89, s89, 2048
    buffer_load_dwordx4 v16, s[52:55], s90 offen lds
    buffer_load_dwordx4 v19, s[52:55], s90 offen offset:1024 lds
    s_add_u32 s90, s90, 16384
    s_cmp_ge_u32 s90, 458752
    s_cselect_b32 s91, 458752, 0
    s_sub_u32 s90, s90, s91
    s_mov_b32 m0, s89
    s_add_u32 s89, s89, 2048
    buffer_load_dwordx4 v16, s[52:55], s90 offen lds
    buffer_load_dwordx4 v19, s[52:55], s90 offen offset:1024 lds
    s_add_u32 s90, s90, 16384
    s_cmp_ge_u32 s90, 458752
    s_cselect_b32 s91, 458752, 0
    s_sub_u32 s90, s90, s91
    s_mov_b32 m0, s89
    s_add_u32 s89, s89, 2048
    buffer_load_dwordx4 v16, s[52:55], s90 offen lds
    buffer_load_dwordx4 v19, s[52:55], s90 offen offset:1024 lds
    s_add_u32 s90, s90, 16384
    s_cmp_ge_u32 s90, 458752
    s_cselect_b32 s91, 458752, 0
    s_sub_u32 s90, s90, s91
    s_mov_b32 m0, s89
    s_add_u32 s89, s89, 2048
    buffer_load_dwordx4 v16, s[52:55], s90 offen lds
    buffer_load_dwordx4 v19, s[52:55], s90 offen offset:1024 lds
    s_add_u32 s90, s90, 16384
    s_cmp_ge_u32 s90, 458752
    s_cselect_b32 s91, 458752, 0
    s_sub_u32 s90, s90, s91
    s_waitcnt vmcnt(0)
    s_mul_i32 s91, s39, 32768
    s_add_u32 s91, s91, 0
    v_add_u32 v30, s91, v17
    v_add_u32 v31, s91, v18
    ds_read_b64_tr_b16 a[60:61], v30 offset:0
    ds_read_b64_tr_b16 a[62:63], v30 offset:1024
    ds_read_b64_tr_b16 a[172:173], v31 offset:0
    ds_read_b64_tr_b16 a[174:175], v31 offset:1024
    ds_read_b64_tr_b16 a[64:65], v30 offset:2048
    ds_read_b64_tr_b16 a[66:67], v30 offset:3072
    ds_read_b64_tr_b16 a[176:177], v31 offset:2048
    ds_read_b64_tr_b16 a[178:179], v31 offset:3072
    ds_read_b64_tr_b16 a[68:69], v30 offset:4096
    ds_read_b64_tr_b16 a[70:71], v30 offset:5120
    ds_read_b64_tr_b16 a[180:181], v31 offset:4096
    ds_read_b64_tr_b16 a[182:183], v31 offset:5120
    ds_read_b64_tr_b16 a[72:73], v30 offset:6144
    ds_read_b64_tr_b16 a[74:75], v30 offset:7168
    ds_read_b64_tr_b16 a[184:185], v31 offset:6144
    ds_read_b64_tr_b16 a[186:187], v31 offset:7168
    ds_read_b64_tr_b16 a[76:77], v30 offset:8192
    ds_read_b64_tr_b16 a[78:79], v30 offset:9216
    ds_read_b64_tr_b16 a[188:189], v31 offset:8192
    ds_read_b64_tr_b16 a[190:191], v31 offset:9216
    ds_read_b64_tr_b16 a[80:81], v30 offset:10240
    ds_read_b64_tr_b16 a[82:83], v30 offset:11264
    ds_read_b64_tr_b16 a[192:193], v31 offset:10240
    ds_read_b64_tr_b16 a[194:195], v31 offset:11264
    ds_read_b64_tr_b16 a[84:85], v30 offset:12288
    ds_read_b64_tr_b16 a[86:87], v30 offset:13312
    ds_read_b64_tr_b16 a[196:197], v31 offset:12288
    ds_read_b64_tr_b16 a[198:199], v31 offset:13312
    ds_read_b64_tr_b16 a[88:89], v30 offset:14336
    ds_read_b64_tr_b16 a[90:91], v30 offset:15360
    ds_read_b64_tr_b16 a[200:201], v31 offset:14336
    ds_read_b64_tr_b16 a[202:203], v31 offset:15360
    ds_read_b64_tr_b16 a[92:93], v30 offset:16384
    ds_read_b64_tr_b16 a[94:95], v30 offset:17408
    ds_read_b64_tr_b16 a[204:205], v31 offset:16384
    ds_read_b64_tr_b16 a[206:207], v31 offset:17408
    ds_read_b64_tr_b16 a[96:97], v30 offset:18432
    ds_read_b64_tr_b16 a[98:99], v30 offset:19456
    ds_read_b64_tr_b16 a[208:209], v31 offset:18432
    ds_read_b64_tr_b16 a[210:211], v31 offset:19456
    ds_read_b64_tr_b16 a[100:101], v30 offset:20480
    ds_read_b64_tr_b16 a[102:103], v30 offset:21504
    ds_read_b64_tr_b16 a[212:213], v31 offset:20480
    ds_read_b64_tr_b16 a[214:215], v31 offset:21504
    ds_read_b64_tr_b16 a[104:105], v30 offset:22528
    ds_read_b64_tr_b16 a[106:107], v30 offset:23552
    ds_read_b64_tr_b16 a[216:217], v31 offset:22528
    ds_read_b64_tr_b16 a[218:219], v31 offset:23552
    ds_read_b64_tr_b16 a[108:109], v30 offset:24576
    ds_read_b64_tr_b16 a[110:111], v30 offset:25600
    ds_read_b64_tr_b16 a[220:221], v31 offset:24576
    ds_read_b64_tr_b16 a[222:223], v31 offset:25600
    s_waitcnt lgkmcnt(0)
    s_barrier
L_skipD2:
    s_lshr_b32 s60, s41, 3
    s_lshl_b32 s61, s40, 2
    s_add_u32 s60, s60, s61
    s_and_b32 s61, s41, 7
    s_lshr_b32 s62, s60, 1
    s_mul_i32 s63, s62, 1792
    s_add_u32 s63, s63, 196608
    v_min_u32 v2, 13, v1
    v_lshlrev_b32 v2, 7, v2
    s_mov_b32 s83, 0
L_polldf_17:
    buffer_load_dword v3, v2, s[44:47], s63 offen sc1
    s_waitcnt vmcnt(0)
    v_cmp_ne_u32 vcc, s38, v3
    s_add_u32 s83, s83, 1
    s_cmp_ge_u32 s83, 65536
    s_cbranch_scc1 L_polldf_done_18
    s_cbranch_vccnz L_polldf_17
L_polldf_done_18:
    s_and_b32 s65, s39, 1
    v_lshlrev_b32 v6, 4, v1
    s_lshl_b32 s70, s60, 1
    s_add_u32 s70, s70, s65
    s_xor_b32 s71, s70, 1
    s_mul_i32 s70, s70, 114688
    s_mul_i32 s71, s71, 114688
    s_mul_i32 s74, s39, 28672
    s_add_u32 s74, s74, 4194304
    s_add_u32 s70, s70, s74
    s_add_u32 s71, s71, s74
    s_lshl_b32 s76, s88, 10
    v_add_u32 v8, s70, v6
    v_add_u32 v9, s71, v6
    buffer_load_dwordx4 v[96:99], v8, s[44:47], s76 offen sc1
    buffer_load_dwordx4 v[100:103], v9, s[44:47], s76 offen sc1
    s_add_u32 s76, s76, 1024
    s_cmp_ge_u32 s76, 28672
    s_cselect_b32 s77, 28672, 0
    s_sub_u32 s76, s76, s77
    buffer_load_dwordx4 v[104:107], v8, s[44:47], s76 offen sc1
    buffer_load_dwordx4 v[108:111], v9, s[44:47], s76 offen sc1
    s_add_u32 s76, s76, 1024
    s_cmp_ge_u32 s76, 28672
    s_cselect_b32 s77, 28672, 0
    s_sub_u32 s76, s76, s77
    buffer_load_dwordx4 v[112:115], v8, s[44:47], s76 offen sc1
    buffer_load_dwordx4 v[116:119], v9, s[44:47], s76 offen sc1
    s_add_u32 s76, s76, 1024
    s_cmp_ge_u32 s76, 28672
    s_cselect_b32 s77, 28672, 0
    s_sub_u32 s76, s76, s77
    buffer_load_dwordx4 v[120:123], v8, s[44:47], s76 offen sc1
    buffer_load_dwordx4 v[124:127], v9, s[44:47], s76 offen sc1
    s_add_u32 s76, s76, 1024
    s_cmp_ge_u32 s76, 28672
    s_cselect_b32 s77, 28672, 0
    s_sub_u32 s76, s76, s77
    buffer_load_dwordx4 v[128:131], v8, s[44:47], s76 offen sc1
    buffer_load_dwordx4 v[132:135], v9, s[44:47], s76 offen sc1
    s_add_u32 s76, s76, 1024
    s_cmp_ge_u32 s76, 28672
    s_cselect_b32 s77, 28672, 0
    s_sub_u32 s76, s76, s77
    buffer_load_dwordx4 v[136:139], v8, s[44:47], s76 offen sc1
    buffer_load_dwordx4 v[140:143], v9, s[44:47], s76 offen sc1
    s_add_u32 s76, s76, 1024
    s_cmp_ge_u32 s76, 28672
    s_cselect_b32 s77, 28672, 0
    s_sub_u32 s76, s76, s77
    s_lshr_b32 s64, s39, 1
    v_lshrrev_b32 v2, 5, v1
    v_and_b32 v3, 31, v1
    v_lshlrev_b32 v4, 10, v2
    v_lshlrev_b32 v5, 2, v3
    v_add_u32 v4, v4, v5
    s_lshl_b32 s66, s62, 17
    s_lshl_b32 s67, s61, 14
    s_add_u32 s66, s66, s67
    s_lshl_b32 s67, s64, 13
    s_add_u32 s66, s66, s67
    s_and_b32 s67, s60, 1
    s_lshl_b32 s67, s67, 8
    s_add_u32 s66, s66, s67
    s_lshl_b32 s67, s65, 7
    s_add_u32 s66, s66, s67
    s_add_u32 s66, s66, 1048576
    s_add_u32 s67, s66, 4096
    s_lshl_b32 s68, s61, 7
    s_lshl_b32 s69, s64, 6
    s_add_u32 s68, s68, s69
    v_lshlrev_b32 v5, 3, v2
    v_add_u32 v5, s68, v5
    s_lshl_b32 s72, s60, 6
    s_lshl_b32 s73, s65, 5
    s_add_u32 s72, s72, s73
    s_lshl_b32 s72, s72, 4
    s_add_u32 s72, s72, 327680
    v_lshlrev_b32 v10, 4, v3
    s_xor_b32 s74, s39, 1
    s_mul_i32 s74, s74, 12288
    s_add_u32 s74, s74, 0
    v_add_u32 v12, s74, v6
    s_xor_b32 s74, s39, 2
    s_mul_i32 s74, s74, 12288
    s_add_u32 s74, s74, 4096
    v_add_u32 v13, s74, v6
    s_xor_b32 s74, s39, 3
    s_mul_i32 s74, s74, 12288
    s_add_u32 s74, s74, 8192
    v_add_u32 v14, s74, v6
    s_mul_i32 s74, s39, 12288
    v_add_u32 v7, s74, v6
    v_lshlrev_b32 v15, 10, v3
    v_lshlrev_b32 v208, 3, v2
    s_lshl_b32 s74, s60, 16
    s_lshl_b32 s75, s65, 15
    s_add_u32 s74, s74, s75
    s_add_u32 s74, s74, s68
    v_add3_u32 v15, v15, v208, s74
    s_waitcnt vmcnt(10)
    v_mfma_f32_32x32x16_bf16 v[32:47], a[0:3], v[96:99], 0
    buffer_load_dwordx4 v[144:147], v8, s[44:47], s76 offen sc1
    buffer_load_dwordx4 v[148:151], v9, s[44:47], s76 offen sc1
    s_add_u32 s76, s76, 1024
    s_cmp_ge_u32 s76, 28672
    s_cselect_b32 s77, 28672, 0
    s_sub_u32 s76, s76, s77
    v_mfma_f32_32x32x16_bf16 v[48:63], a[0:3], v[100:103], 0
    v_mfma_f32_32x32x16_bf16 v[64:79], a[112:115], v[96:99], 0
    v_mfma_f32_32x32x16_bf16 v[80:95], a[112:115], v[100:103], 0
    s_waitcnt vmcnt(10)
    v_mfma_f32_32x32x16_bf16 v[32:47], a[4:7], v[104:107], v[32:47]
    buffer_load_dwordx4 v[152:155], v8, s[44:47], s76 offen sc1
    buffer_load_dwordx4 v[156:159], v9, s[44:47], s76 offen sc1
    s_add_u32 s76, s76, 1024
    s_cmp_ge_u32 s76, 28672
    s_cselect_b32 s77, 28672, 0
    s_sub_u32 s76, s76, s77
    v_mfma_f32_32x32x16_bf16 v[48:63], a[4:7], v[108:111], v[48:63]
    v_mfma_f32_32x32x16_bf16 v[64:79], a[116:119], v[104:107], v[64:79]
    v_mfma_f32_32x32x16_bf16 v[80:95], a[116:119], v[108:111], v[80:95]
    s_waitcnt vmcnt(10)
    v_mfma_f32_32x32x16_bf16 v[32:47], a[8:11], v[112:115], v[32:47]
    buffer_load_dwordx4 v[96:99], v8, s[44:47], s76 offen sc1
    buffer_load_dwordx4 v[100:103], v9, s[44:47], s76 offen sc1
    s_add_u32 s76, s76, 1024
    s_cmp_ge_u32 s76, 28672
    s_cselect_b32 s77, 28672, 0
    s_sub_u32 s76, s76, s77
    v_mfma_f32_32x32x16_bf16 v[48:63], a[8:11], v[116:119], v[48:63]
    buffer_load_dword v16, v4, s[44:47], s66 offen offset:0 sc1
    buffer_load_dword v17, v4, s[44:47], s66 offen offset:512 sc1
    v_mfma_f32_32x32x16_bf16 v[64:79], a[120:123], v[112:115], v[64:79]
    v_mfma_f32_32x32x16_bf16 v[80:95], a[120:123], v[116:119], v[80:95]
    s_waitcnt vmcnt(12)
    v_mfma_f32_32x32x16_bf16 v[32:47], a[12:15], v[120:123], v[32:47]
    buffer_load_dwordx4 v[104:107], v8, s[44:47], s76 offen sc1
    buffer_load_dwordx4 v[108:111], v9, s[44:47], s76 offen sc1
    s_add_u32 s76, s76, 1024
    s_cmp_ge_u32 s76, 28672
    s_cselect_b32 s77, 28672, 0
    s_sub_u32 s76, s76, s77
    v_mfma_f32_32x32x16_bf16 v[48:63], a[12:15], v[124:127], v[48:63]
    buffer_load_dword v18, v4, s[44:47], s66 offen offset:2048 sc1
    buffer_load_dword v19, v4, s[44:47], s66 offen offset:2560 sc1
    v_mfma_f32_32x32x16_bf16 v[64:79], a[124:127], v[120:123], v[64:79]
    v_mfma_f32_32x32x16_bf16 v[80:95], a[124:127], v[124:127], v[80:95]
    s_waitcnt vmcnt(14)
    v_mfma_f32_32x32x16_bf16 v[32:47], a[16:19], v[128:131], v[32:47]
    buffer_load_dwordx4 v[112:115], v8, s[44:47], s76 offen sc1
    buffer_load_dwordx4 v[116:119], v9, s[44:47], s76 offen sc1
    s_add_u32 s76, s76, 1024
    s_cmp_ge_u32 s76, 28672
    s_cselect_b32 s77, 28672, 0
    s_sub_u32 s76, s76, s77
    v_mfma_f32_32x32x16_bf16 v[48:63], a[16:19], v[132:135], v[48:63]
    buffer_load_dword v20, v4, s[44:47], s67 offen offset:0 sc1
    buffer_load_dword v21, v4, s[44:47], s67 offen offset:512 sc1
    v_mfma_f32_32x32x16_bf16 v[64:79], a[128:131], v[128:131], v[64:79]
    v_mfma_f32_32x32x16_bf16 v[80:95], a[128:131], v[132:135], v[80:95]
    s_waitcnt vmcnt(16)
    v_mfma_f32_32x32x16_bf16 v[32:47], a[20:23], v[136:139], v[32:47]
    buffer_load_dwordx4 v[120:123], v8, s[44:47], s76 offen sc1
    buffer_load_dwordx4 v[124:127], v9, s[44:47], s76 offen sc1
    s_add_u32 s76, s76, 1024
    s_cmp_ge_u32 s76, 28672
    s_cselect_b32 s77, 28672, 0
    s_sub_u32 s76, s76, s77
    v_mfma_f32_32x32x16_bf16 v[48:63], a[20:23], v[140:143], v[48:63]
    buffer_load_dword v22, v4, s[44:47], s67 offen offset:2048 sc1
    buffer_load_dword v23, v4, s[44:47], s67 offen offset:2560 sc1
    v_mfma_f32_32x32x16_bf16 v[64:79], a[132:135], v[136:139], v[64:79]
    v_mfma_f32_32x32x16_bf16 v[80:95], a[132:135], v[140:143], v[80:95]
    s_waitcnt vmcnt(18)
    v_mfma_f32_32x32x16_bf16 v[32:47], a[24:27], v[144:147], v[32:47]
    buffer_load_dwordx4 v[128:131], v8, s[44:47], s76 offen sc1
    buffer_load_dwordx4 v[132:135], v9, s[44:47], s76 offen sc1
    s_add_u32 s76, s76, 1024
    s_cmp_ge_u32 s76, 28672
    s_cselect_b32 s77, 28672, 0
    s_sub_u32 s76, s76, s77
    v_mfma_f32_32x32x16_bf16 v[48:63], a[24:27], v[148:151], v[48:63]
    global_load_dwordx2 v[24:25], v5, s[30:31] offset:0
    global_load_dwordx2 v[26:27], v5, s[30:31] offset:16
    v_mfma_f32_32x32x16_bf16 v[64:79], a[136:139], v[144:147], v[64:79]
    v_mfma_f32_32x32x16_bf16 v[80:95], a[136:139], v[148:151], v[80:95]
    s_waitcnt vmcnt(20)
    v_mfma_f32_32x32x16_bf16 v[32:47], a[28:31], v[152:155], v[32:47]
    buffer_load_dwordx4 v[136:139], v8, s[44:47], s76 offen sc1
    buffer_load_dwordx4 v[140:143], v9, s[44:47], s76 offen sc1
    s_add_u32 s76, s76, 1024
    s_cmp_ge_u32 s76, 28672
    s_cselect_b32 s77, 28672, 0
    s_sub_u32 s76, s76, s77
    v_mfma_f32_32x32x16_bf16 v[48:63], a[28:31], v[156:159], v[48:63]
    global_load_dwordx2 v[28:29], v5, s[30:31] offset:32
    global_load_dwordx2 v[30:31], v5, s[30:31] offset:48
    v_mfma_f32_32x32x16_bf16 v[64:79], a[140:143], v[152:155], v[64:79]
    v_mfma_f32_32x32x16_bf16 v[80:95], a[140:143], v[156:159], v[80:95]
    s_waitcnt vmcnt(22)
    v_mfma_f32_32x32x16_bf16 v[32:47], a[32:35], v[96:99], v[32:47]
    buffer_load_dwordx4 v[144:147], v8, s[44:47], s76 offen sc1
    buffer_load_dwordx4 v[148:151], v9, s[44:47], s76 offen sc1
    s_add_u32 s76, s76, 1024
    s_cmp_ge_u32 s76, 28672
    s_cselect_b32 s77, 28672, 0
    s_sub_u32 s76, s76, s77
    v_mfma_f32_32x32x16_bf16 v[48:63], a[32:35], v[100:103], v[48:63]
    buffer_load_dword v11, v10, s[44:47], s72 offen sc1
    v_mfma_f32_32x32x16_bf16 v[64:79], a[144:147], v[96:99], v[64:79]
    v_mfma_f32_32x32x16_bf16 v[80:95], a[144:147], v[100:103], v[80:95]
    s_waitcnt vmcnt(21)
    v_mfma_f32_32x32x16_bf16 v[32:47], a[36:39], v[104:107], v[32:47]
    buffer_load_dwordx4 v[152:155], v8, s[44:47], s76 offen sc1
    buffer_load_dwordx4 v[156:159], v9, s[44:47], s76 offen sc1
    s_add_u32 s76, s76, 1024
    s_cmp_ge_u32 s76, 28672
    s_cselect_b32 s77, 28672, 0
    s_sub_u32 s76, s76, s77
    v_mfma_f32_32x32x16_bf16 v[48:63], a[36:39], v[108:111], v[48:63]
    v_mfma_f32_32x32x16_bf16 v[64:79], a[148:151], v[104:107], v[64:79]
    v_mfma_f32_32x32x16_bf16 v[80:95], a[148:151], v[108:111], v[80:95]
    s_waitcnt vmcnt(19)
    v_mfma_f32_32x32x16_bf16 v[32:47], a[40:43], v[112:115], v[32:47]
    buffer_load_dwordx4 v[96:99], v8, s[44:47], s76 offen sc1
    buffer_load_dwordx4 v[100:103], v9, s[44:47], s76 offen sc1
    s_add_u32 s76, s76, 1024
    s_cmp_ge_u32 s76, 28672
    s_cselect_b32 s77, 28672, 0
    s_sub_u32 s76, s76, s77
    v_mfma_f32_32x32x16_bf16 v[48:63], a[40:43], v[116:119], v[48:63]
    v_mfma_f32_32x32x16_bf16 v[64:79], a[152:155], v[112:115], v[64:79]
    v_mfma_f32_32x32x16_bf16 v[80:95], a[152:155], v[116:119], v[80:95]
    s_waitcnt vmcnt(17)
    v_mfma_f32_32x32x16_bf16 v[32:47], a[44:47], v[120:123], v[32:47]
    buffer_load_dwordx4 v[104:107], v8, s[44:47], s76 offen sc1
    buffer_load_dwordx4 v[108:111], v9, s[44:47], s76 offen sc1
    s_add_u32 s76, s76, 1024
    s_cmp_ge_u32 s76, 28672
    s_cselect_b32 s77, 28672, 0
    s_sub_u32 s76, s76, s77
    v_mfma_f32_32x32x16_bf16 v[48:63], a[44:47], v[124:127], v[48:63]
    v_mfma_f32_32x32x16_bf16 v[64:79], a[156:159], v[120:123], v[64:79]
    v_mfma_f32_32x32x16_bf16 v[80:95], a[156:159], v[124:127], v[80:95]
    s_waitcnt vmcnt(15)
    v_mfma_f32_32x32x16_bf16 v[32:47], a[48:51], v[128:131], v[32:47]
    buffer_load_dwordx4 v[112:115], v8, s[44:47], s76 offen sc1
    buffer_load_dwordx4 v[116:119], v9, s[44:47], s76 offen sc1
    s_add_u32 s76, s76, 1024
    s_cmp_ge_u32 s76, 28672
    s_cselect_b32 s77, 28672, 0
    s_sub_u32 s76, s76, s77
    v_mfma_f32_32x32x16_bf16 v[48:63], a[48:51], v[132:135], v[48:63]
    v_mfma_f32_32x32x16_bf16 v[64:79], a[160:163], v[128:131], v[64:79]
    v_mfma_f32_32x32x16_bf16 v[80:95], a[160:163], v[132:135], v[80:95]
    s_waitcnt vmcnt(13)
    v_mfma_f32_32x32x16_bf16 v[32:47], a[52:55], v[136:139], v[32:47]
    buffer_load_dwordx4 v[120:123], v8, s[44:47], s76 offen sc1
    buffer_load_dwordx4 v[124:127], v9, s[44:47], s76 offen sc1
    s_add_u32 s76, s76, 1024
    s_cmp_ge_u32 s76, 28672
    s_cselect_b32 s77, 28672, 0
    s_sub_u32 s76, s76, s77
    v_mfma_f32_32x32x16_bf16 v[48:63], a[52:55], v[140:143], v[48:63]
    v_mfma_f32_32x32x16_bf16 v[64:79], a[164:167], v[136:139], v[64:79]
    v_mfma_f32_32x32x16_bf16 v[80:95], a[164:167], v[140:143], v[80:95]
    s_waitcnt vmcnt(11)
    v_mfma_f32_32x32x16_bf16 v[32:47], a[56:59], v[144:147], v[32:47]
    buffer_load_dwordx4 v[128:131], v8, s[44:47], s76 offen sc1
    buffer_load_dwordx4 v[132:135], v9, s[44:47], s76 offen sc1
    s_add_u32 s76, s76, 1024
    s_cmp_ge_u32 s76, 28672
    s_cselect_b32 s77, 28672, 0
    s_sub_u32 s76, s76, s77
    v_mfma_f32_32x32x16_bf16 v[48:63], a[56:59], v[148:151], v[48:63]
    v_mfma_f32_32x32x16_bf16 v[64:79], a[168:171], v[144:147], v[64:79]
    v_mfma_f32_32x32x16_bf16 v[80:95], a[168:171], v[148:151], v[80:95]
    s_waitcnt vmcnt(10)
    v_mfma_f32_32x32x16_bf16 v[32:47], a[60:63], v[152:155], v[32:47]
    buffer_load_dwordx4 v[136:139], v8, s[44:47], s76 offen sc1
    buffer_load_dwordx4 v[140:143], v9, s[44:47], s76 offen sc1
    s_add_u32 s76, s76, 1024
    s_cmp_ge_u32 s76, 28672
    s_cselect_b32 s77, 28672, 0
    s_sub_u32 s76, s76, s77
    v_mfma_f32_32x32x16_bf16 v[48:63], a[60:63], v[156:159], v[48:63]
    v_mfma_f32_32x32x16_bf16 v[64:79], a[172:175], v[152:155], v[64:79]
    v_mfma_f32_32x32x16_bf16 v[80:95], a[172:175], v[156:159], v[80:95]
    s_waitcnt vmcnt(10)
    v_mfma_f32_32x32x16_bf16 v[32:47], a[64:67], v[96:99], v[32:47]
    buffer_load_dwordx4 v[144:147], v8, s[44:47], s76 offen sc1
    buffer_load_dwordx4 v[148:151], v9, s[44:47], s76 offen sc1
    s_add_u32 s76, s76, 1024
    s_cmp_ge_u32 s76, 28672
    s_cselect_b32 s77, 28672, 0
    s_sub_u32 s76, s76, s77
    v_mfma_f32_32x32x16_bf16 v[48:63], a[64:67], v[100:103], v[48:63]
    v_mfma_f32_32x32x16_bf16 v[64:79], a[176:179], v[96:99], v[64:79]
    v_mfma_f32_32x32x16_bf16 v[80:95], a[176:179], v[100:103], v[80:95]
    s_waitcnt vmcnt(10)
    v_mfma_f32_32x32x16_bf16 v[32:47], a[68:71], v[104:107], v[32:47]
    buffer_load_dwordx4 v[152:155], v8, s[44:47], s76 offen sc1
    buffer_load_dwordx4 v[156:159], v9, s[44:47], s76 offen sc1
    s_add_u32 s76, s76, 1024
    s_cmp_ge_u32 s76, 28672
    s_cselect_b32 s77, 28672, 0
    s_sub_u32 s76, s76, s77
    v_mfma_f32_32x32x16_bf16 v[48:63], a[68:71], v[108:111], v[48:63]
    v_mfma_f32_32x32x16_bf16 v[64:79], a[180:183], v[104:107], v[64:79]
    v_mfma_f32_32x32x16_bf16 v[80:95], a[180:183], v[108:111], v[80:95]
    s_waitcnt vmcnt(10)
    v_mfma_f32_32x32x16_bf16 v[32:47], a[72:75], v[112:115], v[32:47]
    buffer_load_dwordx4 v[96:99], v8, s[44:47], s76 offen sc1
    buffer_load_dwordx4 v[100:103], v9, s[44:47], s76 offen sc1
    s_add_u32 s76, s76, 1024
    s_cmp_ge_u32 s76, 28672
    s_cselect_b32 s77, 28672, 0
    s_sub_u32 s76, s76, s77
    v_mfma_f32_32x32x16_bf16 v[48:63], a[72:75], v[116:119], v[48:63]
    v_mfma_f32_32x32x16_bf16 v[64:79], a[184:187], v[112:115], v[64:79]
    v_mfma_f32_32x32x16_bf16 v[80:95], a[184:187], v[116:119], v[80:95]
    s_waitcnt vmcnt(10)
    v_mfma_f32_32x32x16_bf16 v[32:47], a[76:79], v[120:123], v[32:47]
    buffer_load_dwordx4 v[104:107], v8, s[44:47], s76 offen sc1
    buffer_load_dwordx4 v[108:111], v9, s[44:47], s76 offen sc1
    s_add_u32 s76, s76, 1024
    s_cmp_ge_u32 s76, 28672
    s_cselect_b32 s77, 28672, 0
    s_sub_u32 s76, s76, s77
    v_mfma_f32_32x32x16_bf16 v[48:63], a[76:79], v[124:127], v[48:63]
    v_lshlrev_b32 v176, 16, v24
    v_and_b32 v177, 0xffff0000, v24
    v_mfma_f32_32x32x16_bf16 v[64:79], a[188:191], v[120:123], v[64:79]
    v_lshlrev_b32 v192, 16, v16
    v_and_b32 v193, 0xffff0000, v16
    v_mfma_f32_32x32x16_bf16 v[80:95], a[188:191], v[124:127], v[80:95]
    v_lshlrev_b32 v178, 16, v25
    v_and_b32 v179, 0xffff0000, v25
    s_waitcnt vmcnt(10)
    v_mfma_f32_32x32x16_bf16 v[32:47], a[80:83], v[128:131], v[32:47]
    buffer_load_dwordx4 v[112:115], v8, s[44:47], s76 offen sc1
    buffer_load_dwordx4 v[116:119], v9, s[44:47], s76 offen sc1
    s_add_u32 s76, s76, 1024
    s_cmp_ge_u32 s76, 28672
    s_cselect_b32 s77, 28672, 0
    s_sub_u32 s76, s76, s77
    v_mfma_f32_32x32x16_bf16 v[48:63], a[80:83], v[132:135], v[48:63]
    v_lshlrev_b32 v194, 16, v17
    v_and_b32 v195, 0xffff0000, v17
    v_mfma_f32_32x32x16_bf16 v[64:79], a[192:195], v[128:131], v[64:79]
    v_lshlrev_b32 v180, 16, v26
    v_and_b32 v181, 0xffff0000, v26
    v_mfma_f32_32x32x16_bf16 v[80:95], a[192:195], v[132:135], v[80:95]
    v_lshlrev_b32 v196, 16, v18
    v_and_b32 v197, 0xffff0000, v18
    s_waitcnt vmcnt(10)
    v_mfma_f32_32x32x16_bf16 v[32:47], a[84:87], v[136:139], v[32:47]
    buffer_load_dwordx4 v[120:123], v8, s[44:47], s76 offen sc1
    buffer_load_dwordx4 v[124:127], v9, s[44:47], s76 offen sc1
    s_add_u32 s76, s76, 1024
    s_cmp_ge_u32 s76, 28672
    s_cselect_b32 s77, 28672, 0
    s_sub_u32 s76, s76, s77
    v_mfma_f32_32x32x16_bf16 v[48:63], a[84:87], v[140:143], v[48:63]
    v_lshlrev_b32 v182, 16, v27
    v_and_b32 v183, 0xffff0000, v27
    v_mfma_f32_32x32x16_bf16 v[64:79], a[196:199], v[136:139], v[64:79]
    v_lshlrev_b32 v198, 16, v19
    v_and_b32 v199, 0xffff0000, v19
    v_mfma_f32_32x32x16_bf16 v[80:95], a[196:199], v[140:143], v[80:95]
    v_lshlrev_b32 v184, 16, v28
    v_and_b32 v185, 0xffff0000, v28
    s_waitcnt vmcnt(10)
    v_mfma_f32_32x32x16_bf16 v[32:47], a[88:91], v[144:147], v[32:47]
    v_mfma_f32_32x32x16_bf16 v[48:63], a[88:91], v[148:151], v[48:63]
    v_lshlrev_b32 v200, 16, v20
    v_and_b32 v201, 0xffff0000, v20
    v_mfma_f32_32x32x16_bf16 v[64:79], a[200:203], v[144:147], v[64:79]
    v_lshlrev_b32 v186, 16, v29
    v_and_b32 v187, 0xffff0000, v29
    v_mfma_f32_32x32x16_bf16 v[80:95], a[200:203], v[148:151], v[80:95]
    v_lshlrev_b32 v202, 16, v21
    v_and_b32 v203, 0xffff0000, v21
    s_waitcnt vmcnt(8)
    v_mfma_f32_32x32x16_bf16 v[32:47], a[92:95], v[152:155], v[32:47]
    v_mfma_f32_32x32x16_bf16 v[48:63], a[92:95], v[156:159], v[48:63]
    v_lshlrev_b32 v188, 16, v30
    v_and_b32 v189, 0xffff0000, v30
    v_mfma_f32_32x32x16_bf16 v[64:79], a[204:207], v[152:155], v[64:79]
    v_lshlrev_b32 v204, 16, v22
    v_and_b32 v205, 0xffff0000, v22
    v_mfma_f32_32x32x16_bf16 v[80:95], a[204:207], v[156:159], v[80:95]
    v_lshlrev_b32 v190, 16, v31
    v_and_b32 v191, 0xffff0000, v31
    s_waitcnt vmcnt(6)
    v_mfma_f32_32x32x16_bf16 v[32:47], a[96:99], v[96:99], v[32:47]
    v_mfma_f32_32x32x16_bf16 v[48:63], a[96:99], v[100:103], v[48:63]
    v_lshlrev_b32 v206, 16, v23
    v_and_b32 v207, 0xffff0000, v23
    v_mfma_f32_32x32x16_bf16 v[64:79], a[208:211], v[96:99], v[64:79]
    v_rcp_f32 v11, v11
    v_mfma_f32_32x32x16_bf16 v[80:95], a[208:211], v[100:103], v[80:95]
    s_waitcnt vmcnt(4)
    v_mfma_f32_32x32x16_bf16 v[32:47], a[100:103], v[104:107], v[32:47]
    v_mfma_f32_32x32x16_bf16 v[48:63], a[100:103], v[108:111], v[48:63]
    v_mfma_f32_32x32x16_bf16 v[64:79], a[212:215], v[104:107], v[64:79]
    v_mfma_f32_32x32x16_bf16 v[80:95], a[212:215], v[108:111], v[80:95]
    s_waitcnt vmcnt(2)
    v_mfma_f32_32x32x16_bf16 v[32:47], a[104:107], v[112:115], v[32:47]
    v_mfma_f32_32x32x16_bf16 v[48:63], a[104:107], v[116:119], v[48:63]
    v_mfma_f32_32x32x16_bf16 v[64:79], a[216:219], v[112:115], v[64:79]
    v_mfma_f32_32x32x16_bf16 v[80:95], a[216:219], v[116:119], v[80:95]
    s_waitcnt vmcnt(0)
    v_mfma_f32_32x32x16_bf16 v[48:63], a[108:111], v[124:127], v[48:63]
    v_mfma_f32_32x32x16_bf16 v[64:79], a[220:223], v[120:123], v[64:79]
    v_mfma_f32_32x32x16_bf16 v[80:95], a[220:223], v[124:127], v[80:95]
    v_mfma_f32_32x32x16_bf16 v[32:47], a[108:111], v[120:123], v[32:47]
    s_nop 8
    ds_write_b128 v12, v[48:51] offset:0
    ds_write_b128 v12, v[52:55] offset:1024
    ds_write_b128 v12, v[56:59] offset:2048
    ds_write_b128 v12, v[60:63] offset:3072
    ds_write_b128 v13, v[64:67] offset:0
    ds_write_b128 v13, v[68:71] offset:1024
    ds_write_b128 v13, v[72:75] offset:2048
    ds_write_b128 v13, v[76:79] offset:3072
    ds_write_b128 v14, v[80:83] offset:0
    ds_write_b128 v14, v[84:87] offset:1024
    ds_write_b128 v14, v[88:91] offset:2048
    ds_write_b128 v14, v[92:95] offset:3072
    s_waitcnt lgkmcnt(0)
    s_barrier
    ds_read_b128 v[96:99], v7 offset:0
    ds_read_b128 v[100:103], v7 offset:1024
    ds_read_b128 v[104:107], v7 offset:2048
    ds_read_b128 v[108:111], v7 offset:3072
    ds_read_b128 v[112:115], v7 offset:4096
    ds_read_b128 v[116:119], v7 offset:5120
    ds_read_b128 v[120:123], v7 offset:6144
    ds_read_b128 v[124:127], v7 offset:7168
    ds_read_b128 v[128:131], v7 offset:8192
    ds_read_b128 v[132:135], v7 offset:9216
    ds_read_b128 v[136:139], v7 offset:10240
    ds_read_b128 v[140:143], v7 offset:11264
    s_waitcnt lgkmcnt(8)
    v_pk_add_f32 v[32:33], v[32:33], v[96:97]
    v_pk_add_f32 v[34:35], v[34:35], v[98:99]
    v_pk_add_f32 v[36:37], v[36:37], v[100:101]
    v_pk_add_f32 v[38:39], v[38:39], v[102:103]
    v_pk_add_f32 v[40:41], v[40:41], v[104:105]
    v_pk_add_f32 v[42:43], v[42:43], v[106:107]
    v_pk_add_f32 v[44:45], v[44:45], v[108:109]
    v_pk_add_f32 v[46:47], v[46:47], v[110:111]
    s_waitcnt lgkmcnt(4)
    v_pk_add_f32 v[32:33], v[32:33], v[112:113]
    v_pk_add_f32 v[34:35], v[34:35], v[114:115]
    v_pk_add_f32 v[36:37], v[36:37], v[116:117]
    v_pk_add_f32 v[38:39], v[38:39], v[118:119]
    v_pk_add_f32 v[40:41], v[40:41], v[120:121]
    v_pk_add_f32 v[42:43], v[42:43], v[122:123]
    v_pk_add_f32 v[44:45], v[44:45], v[124:125]
    v_pk_add_f32 v[46:47], v[46:47], v[126:127]
    s_waitcnt lgkmcnt(0)
    v_pk_add_f32 v[32:33], v[32:33], v[128:129]
    v_pk_add_f32 v[34:35], v[34:35], v[130:131]
    v_pk_add_f32 v[36:37], v[36:37], v[132:133]
    v_pk_add_f32 v[38:39], v[38:39], v[134:135]
    v_pk_add_f32 v[40:41], v[40:41], v[136:137]
    v_pk_add_f32 v[42:43], v[42:43], v[138:139]
    v_pk_add_f32 v[44:45], v[44:45], v[140:141]
    v_pk_add_f32 v[46:47], v[46:47], v[142:143]
    v_pk_mul_f32 v[32:33], v[32:33], v[10:11] op_sel:[0,1] op_sel_hi:[1,1]
    v_pk_mul_f32 v[34:35], v[34:35], v[10:11] op_sel:[0,1] op_sel_hi:[1,1]
    v_pk_mul_f32 v[36:37], v[36:37], v[10:11] op_sel:[0,1] op_sel_hi:[1,1]
    v_pk_mul_f32 v[38:39], v[38:39], v[10:11] op_sel:[0,1] op_sel_hi:[1,1]
    v_pk_mul_f32 v[40:41], v[40:41], v[10:11] op_sel:[0,1] op_sel_hi:[1,1]
    v_pk_mul_f32 v[42:43], v[42:43], v[10:11] op_sel:[0,1] op_sel_hi:[1,1]
    v_pk_mul_f32 v[44:45], v[44:45], v[10:11] op_sel:[0,1] op_sel_hi:[1,1]
    v_pk_mul_f32 v[46:47], v[46:47], v[10:11] op_sel:[0,1] op_sel_hi:[1,1]
    v_cvt_pk_bf16_f32 v160, v32, v33
    v_cvt_pk_bf16_f32 v161, v34, v35
    v_cvt_pk_bf16_f32 v162, v36, v37
    v_cvt_pk_bf16_f32 v163, v38, v39
    v_cvt_pk_bf16_f32 v164, v40, v41
    v_cvt_pk_bf16_f32 v165, v42, v43
    v_cvt_pk_bf16_f32 v166, v44, v45
    v_cvt_pk_bf16_f32 v167, v46, v47
    v_lshlrev_b32 v32, 16, v160
    v_and_b32 v33, 0xffff0000, v160
    v_lshlrev_b32 v34, 16, v161
    v_and_b32 v35, 0xffff0000, v161
    v_lshlrev_b32 v36, 16, v162
    v_and_b32 v37, 0xffff0000, v162
    v_lshlrev_b32 v38, 16, v163
    v_and_b32 v39, 0xffff0000, v163
    v_lshlrev_b32 v40, 16, v164
    v_and_b32 v41, 0xffff0000, v164
    v_lshlrev_b32 v42, 16, v165
    v_and_b32 v43, 0xffff0000, v165
    v_lshlrev_b32 v44, 16, v166
    v_and_b32 v45, 0xffff0000, v166
    v_lshlrev_b32 v46, 16, v167
    v_and_b32 v47, 0xffff0000, v167
    v_pk_add_f32 v[32:33], v[32:33], v[176:177]
    v_pk_add_f32 v[34:35], v[34:35], v[178:179]
    v_pk_add_f32 v[36:37], v[36:37], v[180:181]
    v_pk_add_f32 v[38:39], v[38:39], v[182:183]
    v_pk_add_f32 v[40:41], v[40:41], v[184:185]
    v_pk_add_f32 v[42:43], v[42:43], v[186:187]
    v_pk_add_f32 v[44:45], v[44:45], v[188:189]
    v_pk_add_f32 v[46:47], v[46:47], v[190:191]
    v_cvt_pk_bf16_f32 v160, v32, v33
    v_cvt_pk_bf16_f32 v161, v34, v35
    v_cvt_pk_bf16_f32 v162, v36, v37
    v_cvt_pk_bf16_f32 v163, v38, v39
    v_cvt_pk_bf16_f32 v164, v40, v41
    v_cvt_pk_bf16_f32 v165, v42, v43
    v_cvt_pk_bf16_f32 v166, v44, v45
    v_cvt_pk_bf16_f32 v167, v46, v47
    v_lshlrev_b32 v32, 16, v160
    v_and_b32 v33, 0xffff0000, v160
    v_lshlrev_b32 v34, 16, v161
    v_and_b32 v35, 0xffff0000, v161
    v_lshlrev_b32 v36, 16, v162
    v_and_b32 v37, 0xffff0000, v162
    v_lshlrev_b32 v38, 16, v163
    v_and_b32 v39, 0xffff0000, v163
    v_lshlrev_b32 v40, 16, v164
    v_and_b32 v41, 0xffff0000, v164
    v_lshlrev_b32 v42, 16, v165
    v_and_b32 v43, 0xffff0000, v165
    v_lshlrev_b32 v44, 16, v166
    v_and_b32 v45, 0xffff0000, v166
    v_lshlrev_b32 v46, 16, v167
    v_and_b32 v47, 0xffff0000, v167
    v_pk_add_f32 v[32:33], v[32:33], v[192:193]
    v_pk_add_f32 v[34:35], v[34:35], v[194:195]
    v_pk_add_f32 v[36:37], v[36:37], v[196:197]
    v_pk_add_f32 v[38:39], v[38:39], v[198:199]
    v_pk_add_f32 v[40:41], v[40:41], v[200:201]
    v_pk_add_f32 v[42:43], v[42:43], v[202:203]
    v_pk_add_f32 v[44:45], v[44:45], v[204:205]
    v_pk_add_f32 v[46:47], v[46:47], v[206:207]
    v_cvt_pk_bf16_f32 v160, v32, v33
    v_cvt_pk_bf16_f32 v161, v34, v35
    v_cvt_pk_bf16_f32 v162, v36, v37
    v_cvt_pk_bf16_f32 v163, v38, v39
    v_cvt_pk_bf16_f32 v164, v40, v41
    v_cvt_pk_bf16_f32 v165, v42, v43
    v_cvt_pk_bf16_f32 v166, v44, v45
    v_cvt_pk_bf16_f32 v167, v46, v47
    global_store_dwordx2 v15, v[160:161], s[32:33] offset:0
    global_store_dwordx2 v15, v[162:163], s[32:33] offset:16
    global_store_dwordx2 v15, v[164:165], s[32:33] offset:32
    global_store_dwordx2 v15, v[166:167], s[32:33] offset:48
    s_cmp_lg_u32 s2, 0
    s_cbranch_scc1 L_ep_19
    s_cmp_lg_u32 s39, 0
    s_cbranch_scc1 L_ep_19
    v_mov_b32 v5, 0
    v_mov_b32 v6, s38
    s_mov_b64 exec, 1
    buffer_store_dword v6, v5, s[44:47], 0 offen sc1
L_ep_19:
L_end:
    s_endpgm
.p2align 6
L_gtab:
.short 10752,0,512,1024,1536,2048,2560,3072,3584,0,0,0,0,0,0,0
.short 3584,4,516,1028,1540,2052,2564,3076,3588,0,0,0,0,0,0,0
.short 3588,8,520,1032,1544,2056,2568,3080,3592,0,0,0,0,0,0,0
.short 3592,12,524,1036,1548,2060,2572,3084,3596,0,0,0,0,0,0,0
.short 3596,16,528,1040,1552,2064,2576,3088,3600,0,0,0,0,0,0,0
.short 3600,20,532,1044,1556,2068,2580,3092,3604,0,0,0,0,0,0,0
.short 3604,24,536,1048,1560,2072,2584,3096,3608,0,0,0,0,0,0,0
.short 3608,28,540,1052,1564,2076,2588,3100,3612,0,0,0,0,0,0,0
.short 3612,32,544,1056,1568,2080,2592,3104,3616,0,0,0,0,0,0,0
.short 3616,36,548,1060,1572,2084,2596,3108,3620,0,0,0,0,0,0,0
.short 3620,40,552,1064,1576,2088,2600,3112,3624,0,0,0,0,0,0,0
.short 3624,44,556,1068,1580,2092,2604,3116,3628,0,0,0,0,0,0,0
.short 3628,48,560,1072,1584,2096,2608,3120,3632,0,0,0,0,0,0,0
.short 3632,52,564,1076,1588,2100,2612,3124,3636,0,0,0,0,0,0,0
.short 3636,56,568,1080,1592,2104,2616,3128,3640,0,0,0,0,0,0,0
.short 3640,60,572,1084,1596,2108,2620,3132,3644,0,0,0,0,0,0,0
.short 3644,64,576,1088,1600,2112,2624,3136,3648,0,0,0,0,0,0,0
.short 3648,68,580,1092,1604,2116,2628,3140,3652,0,0,0,0,0,0,0
.short 3652,72,584,1096,1608,2120,2632,3144,3656,0,0,0,0,0,0,0
.short 3656,76,588,1100,1612,2124,2636,3148,3660,0,0,0,0,0,0,0
.short 3660,80,592,1104,1616,2128,2640,3152,3664,0,0,0,0,0,0,0
.short 3664,84,596,1108,1620,2132,2644,3156,3668,0,0,0,0,0,0,0
.short 3668,88,600,1112,1624,2136,2648,3160,3672,0,0,0,0,0,0,0
.short 3672,92,604,1116,1628,2140,2652,3164,3676,0,0,0,0,0,0,0
.short 3676,96,608,1120,1632,2144,2656,3168,3680,0,0,0,0,0,0,0
.short 3680,100,612,1124,1636,2148,2660,3172,3684,0,0,0,0,0,0,0
.short 3684,104,616,1128,1640,2152,2664,3176,3688,0,0,0,0,0,0,0
.short 3688,108,620,1132,1644,2156,2668,3180,3692,0,0,0,0,0,0,0
.short 3692,112,624,1136,1648,2160,2672,3184,3696,0,0,0,0,0,0,0
.short 3696,116,628,1140,1652,2164,2676,3188,3700,0,0,0,0,0,0,0
.short 3700,120,632,1144,1656,2168,2680,3192,3704,0,0,0,0,0,0,0
.short 3704,124,636,1148,1660,2172,2684,3196,3708,0,0,0,0,0,0,0
.short 3708,4096,4096,4608,5120,5120,5120,5632,4100,0,0,0,0,0,0,0
.short 4100,4100,4100,4612,5124,5124,5124,5636,4104,0,0,0,0,0,0,0
.short 4104,4104,4104,4616,5128,5128,5128,5640,4108,0,0,0,0,0,0,0
.short 4108,4108,4108,4620,5132,5132,5132,5644,4112,0,0,0,0,0,0,0
.short 4112,4112,4112,4624,5136,5136,5136,5648,4116,0,0,0,0,0,0,0
.short 4116,4116,4116,4628,5140,5140,5140,5652,4120,0,0,0,0,0,0,0
.short 4120,4120,4120,4632,5144,5144,5144,5656,4124,0,0,0,0,0,0,0
.short 4124,4124,4124,4636,5148,5148,5148,5660,4128,0,0,0,0,0,0,0
.short 4128,4128,4128,4640,5152,5152,5152,5664,4132,0,0,0,0,0,0,0
.short 4132,4132,4132,4644,5156,5156,5156,5668,4136,0,0,0,0,0,0,0
.short 4136,4136,4136,4648,5160,5160,5160,5672,4140,0,0,0,0,0,0,0
.short 4140,4140,4140,4652,5164,5164,5164,5676,4144,0,0,0,0,0,0,0
.short 4144,4144,4144,4656,5168,5168,5168,5680,4148,0,0,0,0,0,0,0
.short 4148,4148,4148,4660,5172,5172,5172,5684,4152,0,0,0,0,0,0,0
.short 4152,4152,4152,4664,5176,5176,5176,5688,4156,0,0,0,0,0,0,0
.short 4156,4156,4156,4668,5180,5180,5180,5692,4160,0,0,0,0,0,0,0
.short 4160,4160,4160,4672,5184,5184,5184,5696,4164,0,0,0,0,0,0,0
.short 4164,4164,4164,4676,5188,5188,5188,5700,4168,0,0,0,0,0,0,0
.short 4168,4168,4168,4680,5192,5192,5192,5704,4172,0,0,0,0,0,0,0
.short 4172,4172,4172,4684,5196,5196,5196,5708,4176,0,0,0,0,0,0,0
.short 4176,4176,4176,4688,5200,5200,5200,5712,4180,0,0,0,0,0,0,0
.short 4180,4180,4180,4692,5204,5204,5204,5716,4184,0,0,0,0,0,0,0
.short 4184,4184,4184,4696,5208,5208,5208,5720,4188,0,0,0,0,0,0,0
.short 4188,4188,4188,4700,5212,5212,5212,5724,4192,0,0,0,0,0,0,0
.short 4192,4192,4192,4704,5216,5216,5216,5728,4196,0,0,0,0,0,0,0
.short 4196,4196,4196,4708,5220,5220,5220,5732,4200,0,0,0,0,0,0,0
.short 4200,4200,4200,4712,5224,5224,5224,5736,4204,0,0,0,0,0,0,0
.short 4204,4204,4204,4716,5228,5228,5228,5740,4208,0,0,0,0,0,0,0
.short 4208,4208,4208,4720,5232,5232,5232,5744,4212,0,0,0,0,0,0,0
.short 4212,4212,4212,4724,5236,5236,5236,5748,4216,0,0,0,0,0,0,0
.short 4216,4216,4216,4728,5240,5240,5240,5752,4220,0,0,0,0,0,0,0
.short 4220,4220,4220,4732,5244,5244,5244,5756,6144,0,0,0,0,0,0,0
.short 6144,6144,6144,6144,6656,6656,6656,6148,6148,0,0,0,0,0,0,0
.short 6148,6148,6148,6148,6660,6660,6660,6152,6152,0,0,0,0,0,0,0
.short 6152,6152,6152,6152,6664,6664,6664,6156,6156,0,0,0,0,0,0,0
.short 6156,6156,6156,6156,6668,6668,6668,6160,6160,0,0,0,0,0,0,0
.short 6160,6160,6160,6160,6672,6672,6672,6164,6164,0,0,0,0,0,0,0
.short 6164,6164,6164,6164,6676,6676,6676,6168,6168,0,0,0,0,0,0,0
.short 6168,6168,6168,6168,6680,6680,6680,6172,6172,0,0,0,0,0,0,0
.short 6172,6172,6172,6172,6684,6684,6684,6176,6176,0,0,0,0,0,0,0
.short 6176,6176,6176,6176,6688,6688,6688,6180,6180,0,0,0,0,0,0,0
.short 6180,6180,6180,6180,6692,6692,6692,6184,6184,0,0,0,0,0,0,0
.short 6184,6184,6184,6184,6696,6696,6696,6188,6188,0,0,0,0,0,0,0
.short 6188,6188,6188,6188,6700,6700,6700,6192,6192,0,0,0,0,0,0,0
.short 6192,6192,6192,6192,6704,6704,6704,6196,6196,0,0,0,0,0,0,0
.short 6196,6196,6196,6196,6708,6708,6708,6200,6200,0,0,0,0,0,0,0
.short 6200,6200,6200,6200,6712,6712,6712,6204,6204,0,0,0,0,0,0,0
.short 6204,6204,6204,6204,6716,6716,6716,6208,6208,0,0,0,0,0,0,0
.short 6208,6208,6208,6208,6720,6720,6720,6212,6212,0,0,0,0,0,0,0
.short 6212,6212,6212,6212,6724,6724,6724,6216,6216,0,0,0,0,0,0,0
.short 6216,6216,6216,6216,6728,6728,6728,6220,6220,0,0,0,0,0,0,0
.short 6220,6220,6220,6220,6732,6732,6732,6224,6224,0,0,0,0,0,0,0
.short 6224,6224,6224,6224,6736,6736,6736,6228,6228,0,0,0,0,0,0,0
.short 6228,6228,6228,6228,6740,6740,6740,6232,6232,0,0,0,0,0,0,0
.short 6232,6232,6232,6232,6744,6744,6744,6236,6236,0,0,0,0,0,0,0
.short 6236,6236,6236,6236,6748,6748,6748,6240,6240,0,0,0,0,0,0,0
.short 6240,6240,6240,6240,6752,6752,6752,6244,6244,0,0,0,0,0,0,0
.short 6244,6244,6244,6244,6756,6756,6756,6248,6248,0,0,0,0,0,0,0
.short 6248,6248,6248,6248,6760,6760,6760,6252,6252,0,0,0,0,0,0,0
.short 6252,6252,6252,6252,6764,6764,6764,6256,6256,0,0,0,0,0,0,0
.short 6256,6256,6256,6256,6768,6768,6768,6260,6260,0,0,0,0,0,0,0
.short 6260,6260,6260,6260,6772,6772,6772,6264,6264,0,0,0,0,0,0,0
.short 6264,6264,6264,6264,6776,6776,6776,6268,6268,0,0,0,0,0,0,0
.short 6268,6268,6268,6268,6780,6780,6780,7168,7168,0,0,0,0,0,0,0
.short 7168,7168,7168,7168,7680,7680,7680,7172,7172,0,0,0,0,0,0,0
.short 7172,7172,7172,7172,7684,7684,7684,7176,7176,0,0,0,0,0,0,0
.short 7176,7176,7176,7176,7688,7688,7688,7180,7180,0,0,0,0,0,0,0
.short 7180,7180,7180,7180,7692,7692,7692,7184,7184,0,0,0,0,0,0,0
.short 7184,7184,7184,7184,7696,7696,7696,7188,7188,0,0,0,0,0,0,0
.short 7188,7188,7188,7188,7700,7700,7700,7192,7192,0,0,0,0,0,0,0
.short 7192,7192,7192,7192,7704,7704,7704,7196,7196,0,0,0,0,0,0,0
.short 7196,7196,7196,7196,7708,7708,7708,7200,7200,0,0,0,0,0,0,0
.short 7200,7200,7200,7200,7712,7712,7712,7204,7204,0,0,0,0,0,0,0
.short 7204,7204,7204,7204,7716,7716,7716,7208,7208,0,0,0,0,0,0,0
.short 7208,7208,7208,7208,7720,7720,7720,7212,7212,0,0,0,0,0,0,0
.short 7212,7212,7212,7212,7724,7724,7724,7216,7216,0,0,0,0,0,0,0
.short 7216,7216,7216,7216,7728,7728,7728,7220,7220,0,0,0,0,0,0,0
.short 7220,7220,7220,7220,7732,7732,7732,7224,7224,0,0,0,0,0,0,0
.short 7224,7224,7224,7224,7736,7736,7736,7228,7228,0,0,0,0,0,0,0
.short 7228,7228,7228,7228,7740,7740,7740,7232,7232,0,0,0,0,0,0,0
.short 7232,7232,7232,7232,7744,7744,7744,7236,7236,0,0,0,0,0,0,0
.short 7236,7236,7236,7236,7748,7748,7748,7240,7240,0,0,0,0,0,0,0
.short 7240,7240,7240,7240,7752,7752,7752,7244,7244,0,0,0,0,0,0,0
.short 7244,7244,7244,7244,7756,7756,7756,7248,7248,0,0,0,0,0,0,0
.short 7248,7248,7248,7248,7760,7760,7760,7252,7252,0,0,0,0,0,0,0
.short 7252,7252,7252,7252,7764,7764,7764,7256,7256,0,0,0,0,0,0,0
.short 7256,7256,7256,7256,7768,7768,7768,7260,7260,0,0,0,0,0,0,0
.short 7260,7260,7260,7260,7772,7772,7772,7264,7264,0,0,0,0,0,0,0
.short 7264,7264,7264,7264,7776,7776,7776,7268,7268,0,0,0,0,0,0,0
.short 7268,7268,7268,7268,7780,7780,7780,7272,7272,0,0,0,0,0,0,0
.short 7272,7272,7272,7272,7784,7784,7784,7276,7276,0,0,0,0,0,0,0
.short 7276,7276,7276,7276,7788,7788,7788,7280,7280,0,0,0,0,0,0,0
.short 7280,7280,7280,7280,7792,7792,7792,7284,7284,0,0,0,0,0,0,0
.short 7284,7284,7284,7284,7796,7796,7796,7288,7288,0,0,0,0,0,0,0
.short 7288,7288,7288,7288,7800,7800,7800,7292,7292,0,0,0,0,0,0,0
.short 7292,7292,7292,7292,7804,7804,7804,8192,8192,0,0,0,0,0,0,0
.short 8192,8192,8192,8192,8192,8192,8196,8196,8196,0,0,0,0,0,0,0
.short 8196,8196,8196,8196,8196,8200,8200,8200,8200,0,0,0,0,0,0,0
.short 8200,8200,8200,8200,8200,8200,8204,8204,8204,0,0,0,0,0,0,0
.short 8204,8204,8204,8204,8204,8208,8208,8208,8208,0,0,0,0,0,0,0
.short 8208,8208,8208,8208,8208,8208,8212,8212,8212,0,0,0,0,0,0,0
.short 8212,8212,8212,8212,8212,8216,8216,8216,8216,0,0,0,0,0,0,0
.short 8216,8216,8216,8216,8216,8216,8220,8220,8220,0,0,0,0,0,0,0
.short 8220,8220,8220,8220,8220,8224,8224,8224,8224,0,0,0,0,0,0,0
.short 8224,8224,8224,8224,8224,8224,8228,8228,8228,0,0,0,0,0,0,0
.short 8228,8228,8228,8228,8228,8232,8232,8232,8232,0,0,0,0,0,0,0
.short 8232,8232,8232,8232,8232,8232,8236,8236,8236,0,0,0,0,0,0,0
.short 8236,8236,8236,8236,8236,8240,8240,8240,8240,0,0,0,0,0,0,0
.short 8240,8240,8240,8240,8240,8240,8244,8244,8244,0,0,0,0,0,0,0
.short 8244,8244,8244,8244,8244,8248,8248,8248,8248,0,0,0,0,0,0,0
.short 8248,8248,8248,8248,8248,8248,8252,8252,8252,0,0,0,0,0,0,0
.short 8252,8252,8252,8252,8252,8256,8256,8256,8256,0,0,0,0,0,0,0
.short 8256,8256,8256,8256,8256,8256,8260,8260,8260,0,0,0,0,0,0,0
.short 8260,8260,8260,8260,8260,8264,8264,8264,8264,0,0,0,0,0,0,0
.short 8264,8264,8264,8264,8264,8264,8268,8268,8268,0,0,0,0,0,0,0
.short 8268,8268,8268,8268,8268,8272,8272,8272,8272,0,0,0,0,0,0,0
.short 8272,8272,8272,8272,8272,8272,8276,8276,8276,0,0,0,0,0,0,0
.short 8276,8276,8276,8276,8276,8280,8280,8280,8280,0,0,0,0,0,0,0
.short 8280,8280,8280,8280,8280,8280,8284,8284,8284,0,0,0,0,0,0,0
.short 8284,8284,8284,8284,8284,8288,8288,8288,8288,0,0,0,0,0,0,0
.short 8288,8288,8288,8288,8288,8288,8292,8292,8292,0,0,0,0,0,0,0
.short 8292,8292,8292,8292,8292,8296,8296,8296,8296,0,0,0,0,0,0,0
.short 8296,8296,8296,8296,8296,8296,8300,8300,8300,0,0,0,0,0,0,0
.short 8300,8300,8300,8300,8300,8304,8304,8304,8304,0,0,0,0,0,0,0
.short 8304,8304,8304,8304,8304,8304,8308,8308,8308,0,0,0,0,0,0,0
.short 8308,8308,8308,8308,8308,8312,8312,8312,8312,0,0,0,0,0,0,0
.short 8312,8312,8312,8312,8312,8312,8316,8316,8316,0,0,0,0,0,0,0
.short 8316,8316,8316,8316,8316,8704,8704,8704,8704,0,0,0,0,0,0,0
.short 8704,8704,8704,8704,8704,8704,8708,8708,8708,0,0,0,0,0,0,0
.short 8708,8708,8708,8708,8708,8712,8712,8712,8712,0,0,0,0,0,0,0
.short 8712,8712,8712,8712,8712,8712,8716,8716,8716,0,0,0,0,0,0,0
.short 8716,8716,8716,8716,8716,8720,8720,8720,8720,0,0,0,0,0,0,0
.short 8720,8720,8720,8720,8720,8720,8724,8724,8724,0,0,0,0,0,0,0
.short 8724,8724,8724,8724,8724,8728,8728,8728,8728,0,0,0,0,0,0,0
.short 8728,8728,8728,8728,8728,8728,8732,8732,8732,0,0,0,0,0,0,0
.short 8732,8732,8732,8732,8732,8736,8736,8736,8736,0,0,0,0,0,0,0
.short 8736,8736,8736,8736,8736,8736,8740,8740,8740,0,0,0,0,0,0,0
.short 8740,8740,8740,8740,8740,8744,8744,8744,8744,0,0,0,0,0,0,0
.short 8744,8744,8744,8744,8744,8744,8748,8748,8748,0,0,0,0,0,0,0
.short 8748,8748,8748,8748,8748,8752,8752,8752,8752,0,0,0,0,0,0,0
.short 8752,8752,8752,8752,8752,8752,8756,8756,8756,0,0,0,0,0,0,0
.short 8756,8756,8756,8756,8756,8760,8760,8760,8760,0,0,0,0,0,0,0
.short 8760,8760,8760,8760,8760,8760,8764,8764,8764,0,0,0,0,0,0,0
.short 8764,8764,8764,8764,8764,8768,8768,8768,8768,0,0,0,0,0,0,0
.short 8768,8768,8768,8768,8768,8768,8772,8772,8772,0,0,0,0,0,0,0
.short 8772,8772,8772,8772,8772,8776,8776,8776,8776,0,0,0,0,0,0,0
.short 8776,8776,8776,8776,8776,8776,8780,8780,8780,0,0,0,0,0,0,0
.short 8780,8780,8780,8780,8780,8784,8784,8784,8784,0,0,0,0,0,0,0
.short 8784,8784,8784,8784,8784,8784,8788,8788,8788,0,0,0,0,0,0,0
.short 8788,8788,8788,8788,8788,8792,8792,8792,8792,0,0,0,0,0,0,0
.short 8792,8792,8792,8792,8792,8792,8796,8796,8796,0,0,0,0,0,0,0
.short 8796,8796,8796,8796,8796,8800,8800,8800,8800,0,0,0,0,0,0,0
.short 8800,8800,8800,8800,8800,8800,8804,8804,8804,0,0,0,0,0,0,0
.short 8804,8804,8804,8804,8804,8808,8808,8808,8808,0,0,0,0,0,0,0
.short 8808,8808,8808,8808,8808,8808,8812,8812,8812,0,0,0,0,0,0,0
.short 8812,8812,8812,8812,8812,8816,8816,8816,8816,0,0,0,0,0,0,0
.short 8816,8816,8816,8816,8816,8816,8820,8820,8820,0,0,0,0,0,0,0
.short 8820,8820,8820,8820,8820,8824,8824,8824,8824,0,0,0,0,0,0,0
.short 8824,8824,8824,8824,8824,8824,8828,8828,8828,0,0,0,0,0,0,0
.short 8828,8828,8828,8828,8828,9216,9216,9216,9216,0,0,0,0,0,0,0
.short 9216,9216,9216,9216,9216,9216,9220,9220,9220,0,0,0,0,0,0,0
.short 9220,9220,9220,9220,9220,9224,9224,9224,9224,0,0,0,0,0,0,0
.short 9224,9224,9224,9224,9224,9224,9228,9228,9228,0,0,0,0,0,0,0
.short 9228,9228,9228,9228,9228,9232,9232,9232,9232,0,0,0,0,0,0,0
.short 9232,9232,9232,9232,9232,9232,9236,9236,9236,0,0,0,0,0,0,0
.short 9236,9236,9236,9236,9236,9240,9240,9240,9240,0,0,0,0,0,0,0
.short 9240,9240,9240,9240,9240,9240,9244,9244,9244,0,0,0,0,0,0,0
.short 9244,9244,9244,9244,9244,9248,9248,9248,9248,0,0,0,0,0,0,0
.short 9248,9248,9248,9248,9248,9248,9252,9252,9252,0,0,0,0,0,0,0
.short 9252,9252,9252,9252,9252,9256,9256,9256,9256,0,0,0,0,0,0,0
.short 9256,9256,9256,9256,9256,9256,9260,9260,9260,0,0,0,0,0,0,0
.short 9260,9260,9260,9260,9260,9264,9264,9264,9264,0,0,0,0,0,0,0
.short 9264,9264,9264,9264,9264,9264,9268,9268,9268,0,0,0,0,0,0,0
.short 9268,9268,9268,9268,9268,9272,9272,9272,9272,0,0,0,0,0,0,0
.short 9272,9272,9272,9272,9272,9272,9276,9276,9276,0,0,0,0,0,0,0
.short 9276,9276,9276,9276,9276,9280,9280,9280,9280,0,0,0,0,0,0,0
.short 9280,9280,9280,9280,9280,9280,9284,9284,9284,0,0,0,0,0,0,0
.short 9284,9284,9284,9284,9284,9288,9288,9288,9288,0,0,0,0,0,0,0
.short 9288,9288,9288,9288,9288,9288,9292,9292,9292,0,0,0,0,0,0,0
.short 9292,9292,9292,9292,9292,9296,9296,9296,9296,0,0,0,0,0,0,0
.short 9296,9296,9296,9296,9296,9296,9300,9300,9300,0,0,0,0,0,0,0
.short 9300,9300,9300,9300,9300,9304,9304,9304,9304,0,0,0,0,0,0,0
.short 9304,9304,9304,9304,9304,9304,9308,9308,9308,0,0,0,0,0,0,0
.short 9308,9308,9308,9308,9308,9312,9312,9312,9312,0,0,0,0,0,0,0
.short 9312,9312,9312,9312,9312,9312,9316,9316,9316,0,0,0,0,0,0,0
.short 9316,9316,9316,9316,9316,9320,9320,9320,9320,0,0,0,0,0,0,0
.short 9320,9320,9320,9320,9320,9320,9324,9324,9324,0,0,0,0,0,0,0
.short 9324,9324,9324,9324,9324,9328,9328,9328,9328,0,0,0,0,0,0,0
.short 9328,9328,9328,9328,9328,9328,9332,9332,9332,0,0,0,0,0,0,0
.short 9332,9332,9332,9332,9332,9336,9336,9336,9336,0,0,0,0,0,0,0
.short 9336,9336,9336,9336,9336,9336,9340,9340,9340,0,0,0,0,0,0,0
.short 9340,9340,9340,9340,9340,9728,9728,9728,9728,0,0,0,0,0,0,0
.short 9728,9728,9728,9728,9728,9728,9732,9732,9732,0,0,0,0,0,0,0
.short 9732,9732,9732,9732,9732,9736,9736,9736,9736,0,0,0,0,0,0,0
.short 9736,9736,9736,9736,9736,9736,9740,9740,9740,0,0,0,0,0,0,0
.short 9740,9740,9740,9740,9740,9744,9744,9744,9744,0,0,0,0,0,0,0
.short 9744,9744,9744,9744,9744,9744,9748,9748,9748,0,0,0,0,0,0,0
.short 9748,9748,9748,9748,9748,9752,9752,9752,9752,0,0,0,0,0,0,0
.short 9752,9752,9752,9752,9752,9752,9756,9756,9756,0,0,0,0,0,0,0
.short 9756,9756,9756,9756,9756,9760,9760,9760,9760,0,0,0,0,0,0,0
.short 9760,9760,9760,9760,9760,9760,9764,9764,9764,0,0,0,0,0,0,0
.short 9764,9764,9764,9764,9764,9768,9768,9768,9768,0,0,0,0,0,0,0
.short 9768,9768,9768,9768,9768,9768,9772,9772,9772,0,0,0,0,0,0,0
.short 9772,9772,9772,9772,9772,9776,9776,9776,9776,0,0,0,0,0,0,0
.short 9776,9776,9776,9776,9776,9776,9780,9780,9780,0,0,0,0,0,0,0
.short 9780,9780,9780,9780,9780,9784,9784,9784,9784,0,0,0,0,0,0,0
.short 9784,9784,9784,9784,9784,9784,9788,9788,9788,0,0,0,0,0,0,0
.short 9788,9788,9788,9788,9788,9792,9792,9792,9792,0,0,0,0,0,0,0
.short 9792,9792,9792,9792,9792,9792,9796,9796,9796,0,0,0,0,0,0,0
.short 9796,9796,9796,9796,9796,9800,9800,9800,9800,0,0,0,0,0,0,0
.short 9800,9800,9800,9800,9800,9800,9804,9804,9804,0,0,0,0,0,0,0
.short 9804,9804,9804,9804,9804,9808,9808,9808,9808,0,0,0,0,0,0,0
.short 9808,9808,9808,9808,9808,9808,9812,9812,9812,0,0,0,0,0,0,0
.short 9812,9812,9812,9812,9812,9816,9816,9816,9816,0,0,0,0,0,0,0
.short 9816,9816,9816,9816,9816,9816,9820,9820,9820,0,0,0,0,0,0,0
.short 9820,9820,9820,9820,9820,9824,9824,9824,9824,0,0,0,0,0,0,0
.short 9824,9824,9824,9824,9824,9824,9828,9828,9828,0,0,0,0,0,0,0
.short 9828,9828,9828,9828,9828,9832,9832,9832,9832,0,0,0,0,0,0,0
.short 9832,9832,9832,9832,9832,9832,9836,9836,9836,0,0,0,0,0,0,0
.short 9836,9836,9836,9836,9836,9840,9840,9840,9840,0,0,0,0,0,0,0
.short 9840,9840,9840,9840,9840,9840,9844,9844,9844,0,0,0,0,0,0,0
.short 9844,9844,9844,9844,9844,9848,9848,9848,9848,0,0,0,0,0,0,0
.short 9848,9848,9848,9848,9848,9848,9852,9852,9852,0,0,0,0,0,0,0
.short 9852,9852,9852,9852,9852,10240,10240,10240,10240,0,0,0,0,0,0,0
.section .rodata,"a"
.p2align 6
.amdhsa_kernel sequential_preLN__ssm_conv_s4__mixer_channel_mlp__prompt_kernel
  .amdhsa_next_free_vgpr 512
  .amdhsa_next_free_sgpr 102
  .amdhsa_accum_offset 256
  .amdhsa_group_segment_fixed_size 0
  .amdhsa_kernarg_size 136
  .amdhsa_user_sgpr_count 2
  .amdhsa_user_sgpr_kernarg_segment_ptr 1
  .amdhsa_system_sgpr_workgroup_id_x 1
.end_amdhsa_kernel
```
